```python
import torch

def _softmax(x, axis=-1):
    return torch.softmax(x, dim=axis)
def _gelu(x):
    return torch.nn.functional.gelu(x, approximate="tanh")
def _silu(x):
    return torch.nn.functional.silu(x)
def _sigmoid(x):
    return torch.sigmoid(x)
def _layernorm(x, axis=-1, eps=1e-5):
    m = x.mean(dim=axis, keepdim=True)
    v = x.var(dim=axis, keepdim=True, unbiased=False)
    return (x - m) / torch.sqrt(v + eps)
def _scatter_add(tgt, idx, src, axis=0):
    return tgt.clone().index_add_(axis, idx, src)
def _segment_sum(src, seg, n):
    out = torch.zeros((n,) + src.shape[1:], dtype=src.dtype)
    return out.index_add_(0, seg, src)
def _pad(x, pw):
    flat = tuple(v for pair in reversed(pw) for v in pair)
    return torch.nn.functional.pad(x, flat)

kernel_name = 'gated_mix__linear_kernel_hedgehog__softmax_full_mha__prompt'

def setup_inputs():

    _w = (lambda a: (lambda t: t.to(torch.bfloat16) if t.is_floating_point() else t)(torch.as_tensor(a)))
    def _A_setup():
        B, S, D, H = 1, 2048, 512, 32
        Dh = D // H
        return {
            "x": _w((lambda *s: torch.randn(*s, dtype=torch.bfloat16) * 0.05)(B, S, D)),
            "wqkv": _w((lambda *s: torch.randn(*s, dtype=torch.bfloat16) * 3.2)(D, 3 * D)),
            "w_phi": _w((lambda *s: torch.randn(*s, dtype=torch.bfloat16) * 3.2)(H, Dh, Dh) * (Dh ** -0.5)),
            "wo": _w((lambda *s: torch.randn(*s, dtype=torch.bfloat16) * 0.05)(D, D)),
        }
    _A_in = _A_setup()

    def _B_setup():
        B, S, D = 1, 2048, 512
        return {
            "x": _w((lambda *s: torch.randn(*s, dtype=torch.bfloat16) * 0.05)(B, S, D)),
            "wqkv": _w((lambda *s: torch.randn(*s, dtype=torch.bfloat16) * 1.6)(D, 3 * D)),
            "wo": _w((lambda *s: torch.randn(*s, dtype=torch.bfloat16) * 0.05)(D, D)),
        }
    _B_in = _B_setup()

    return {
        "A_x": _A_in["x"],
        "A_wqkv": _A_in["wqkv"],
        "A_w_phi": _A_in["w_phi"],
        "A_wo": _A_in["wo"],
        "B_x": _B_in["x"],
        "B_wqkv": _B_in["wqkv"],
        "B_wo": _B_in["wo"],
        "gate_w": _w((lambda *s: torch.randn(*s, dtype=torch.bfloat16) * 0.05)(512) * 16.0),
    }

def reference(A_x, A_wqkv, A_w_phi, A_wo, B_x, B_wqkv, B_wo, gate_w):
    def _A_ref(x, wqkv, w_phi, wo):
        B, S, D = x.shape
        H = 32; Dh = D // H
        qkv = (lambda x, *d: x.permute(*d))((x @ wqkv).reshape(B, S, 3, H, Dh), 2, 0, 3, 1, 4)
        q, k, v = qkv[0], qkv[1], qkv[2]
        pq = torch.einsum("bhsd,hdf->bhsf", q, w_phi)
        pk = torch.einsum("bhsd,hdf->bhsf", k, w_phi)
        phi_q = torch.concatenate([_softmax(pq, axis=-1), _softmax(-pq, axis=-1)], axis=-1)
        phi_k = torch.concatenate([_softmax(pk, axis=-1), _softmax(-pk, axis=-1)], axis=-1)
        kv = torch.einsum("bhsf,bhsd->bhfd", phi_k, v)
        z  = torch.einsum("bhsf->bhf", phi_k)
        num = torch.einsum("bhqf,bhfd->bhqd", phi_q, kv)
        den = torch.einsum("bhqf,bhf->bhq", phi_q, z)[..., None] + 1e-6
        o = num / den
        return (lambda x, *d: x.permute(*d))(o, 0, 2, 1, 3).reshape(B, S, D) @ wo

    def _B_ref(x, wqkv, wo):
        B, S, D = x.shape
        H = 32; Dh = D // H
        qkv = (lambda x, *d: x.permute(*d))((x @ wqkv).reshape(B, S, 3, H, Dh), 2, 0, 3, 1, 4)
        q, k, v = qkv[0], qkv[1], qkv[2]
        scale = Dh ** -0.5
        scores = torch.einsum("bhqd,bhkd->bhqk", q, k) * scale
        p = _softmax(scores, axis=-1)
        o = torch.einsum("bhqk,bhkd->bhqd", p, v)
        return (lambda x, *d: x.permute(*d))(o, 0, 2, 1, 3).reshape(B, S, D) @ wo

    x = A_x
    g = _sigmoid((x * gate_w).sum(-1, keepdims=True))
    a = _A_ref(x, A_wqkv, A_w_phi, A_wo)
    b = _B_ref(x, B_wqkv, B_wo)
    return g * a + (1 - g) * b
```

```asm
; @launch kernel=gated_mix__linear_kernel_hedgehog__softmax_full_mha__prompt_kernel grid=(256,1,1) block=(768,1,1) lds=163840
.amdgcn_target "amdgcn-amd-amdhsa--gfx950"
.text
.globl gated_mix__linear_kernel_hedgehog__softmax_full_mha__prompt_kernel
.p2align 8
.type gated_mix__linear_kernel_hedgehog__softmax_full_mha__prompt_kernel,@function
gated_mix__linear_kernel_hedgehog__softmax_full_mha__prompt_kernel:
    s_cmp_ge_u32 s2, 256
    s_cbranch_scc1 K_end
    s_load_dwordx16 s[64:79], s[0:1], 0
    s_load_dwordx4 s[56:59], s[0:1], 64
    s_load_dwordx2 s[60:61], s[0:1], 80
    v_lshrrev_b32 v1, 6, v0
    v_and_b32 v0, 63, v0
    v_readfirstlane_b32 s28, v1
    s_and_b32 s3, s2, 1
    s_lshl_b32 s33, s3, 3
    s_lshr_b32 s3, s2, 3
    s_and_b32 s39, s3, 7
    s_add_u32 s33, s33, s39
    s_lshr_b32 s36, s3, 3
    s_and_b32 s4, s2, 6
    s_lshl_b32 s4, s4, 1
    s_add_u32 s36, s36, s4
    s_and_b32 s37, s36, 7
    s_lshr_b32 s38, s36, 3
    s_cmp_ge_u32 s28, 4
    s_cbranch_scc1 P1_compute
    s_getpc_b64 s[4:5]
P1_pc:
    s_sub_u32 s4, s4, P1_pc-gated_mix__linear_kernel_hedgehog__softmax_full_mha__prompt_kernel
    s_subb_u32 s5, s5, 0
    s_lshl_b32 s3, s28, 13
    v_lshlrev_b32 v12, 7, v0
    v_add_u32 v12, s3, v12
    v_min_u32 v12, K_last-gated_mix__linear_kernel_hedgehog__softmax_full_mha__prompt_kernel, v12
    global_load_dword v13, v12, s[4:5]
    v_lshrrev_b32 v5, 3, v0
    s_lshl_b32 s3, s28, 3
    v_add_u32 v6, s3, v5
    v_lshlrev_b32 v6, 10, v6
    v_lshrrev_b32 v3, 4, v0
    s_and_b32 s3, s28, 1
    s_lshl_b32 s3, s3, 2
    v_add_u32 v3, s3, v3
    v_and_b32 v4, 7, v0
    v_xor_b32 v3, v3, v4
    v_lshlrev_b32 v3, 4, v3
    v_add_u32 v6, v6, v3
    s_lshl_b32 s3, s28, 4
    v_add_u32 v7, s3, v5
    v_mul_u32_u24 v7, 3072, v7
    v_and_b32 v5, 16, v0
    v_lshrrev_b32 v5, 2, v5
    v_xor_b32 v4, v4, v5
    v_lshlrev_b32 v4, 4, v4
    v_add_u32 v7, v7, v4
    v_lshlrev_b32 v1, 4, v0
    v_mov_b32 v2, 135168
    v_lshlrev_b32 v3, 2, v0
    v_add_u32 v3, v2, v3
    v_mov_b32 v4, 0
    ds_write_b32 v3, v4
    s_lshl_b32 s48, s33, 17
    s_lshl_b32 s3, s37, 7
    s_cmp_eq_u32 s38, 0
    s_cselect_b32 s49, 1024, 0
    s_cselect_b32 s29, 2048, 0
    s_max_u32 s30, s29, 1024
    s_add_u32 s49, s49, s3
    s_add_u32 s29, s29, s3
    s_add_u32 s30, s30, s3
    s_lshl_b32 s50, s28, 10
    s_lshl_b32 s31, s28, 11
    s_mov_b32 s51, 0
    s_xor_b32 s39, s39, s36
    s_and_b32 s39, s39, 1
    s_lshl_b32 s39, s39, 2
    s_waitcnt lgkmcnt(0)
    s_mov_b32 s12, s64
    s_mov_b32 s13, s65
    s_mov_b32 s14, 2097152
    s_mov_b32 s15, 0x00020000
    s_mov_b32 s16, s66
    s_mov_b32 s17, s67
    s_mov_b32 s18, 1572864
    s_mov_b32 s19, 0x00020000
    s_mov_b32 s24, s74
    s_mov_b32 s25, s75
    s_mov_b32 s26, 1572864
    s_mov_b32 s27, 0x00020000
    s_cmp_eq_u32 s38, 0
    s_cselect_b32 s4, s66, s74
    s_cselect_b32 s5, s67, s75
    s_mov_b32 s20, s4
    s_mov_b32 s21, s5
    s_mov_b32 s22, 1572864
    s_mov_b32 s23, 0x00020000
    s_mov_b32 s52, s58
    s_mov_b32 s53, s59
    s_mov_b32 s54, 256
    s_mov_b32 s55, 0x00020000
    s_cmp_ge_u32 s28, 2
    s_cbranch_scc1 P1_nophi
    s_mov_b32 s40, s68
    s_mov_b32 s41, s69
    s_mov_b32 s42, 16384
    s_mov_b32 s43, 0x00020000
    s_add_u32 m0, s50, 131072
    s_lshl_b32 s6, s37, 11
    s_add_u32 s6, s6, s50
    buffer_load_dwordx4 v1, s[40:43], s6 offen lds
    s_branch P1_ld_loop
P1_nophi:
    s_cmp_lg_u32 s2, 0
    s_cbranch_scc1 P1_ld_loop
    s_cmp_lg_u32 s28, 3
    s_cbranch_scc1 P1_ld_loop
    s_memrealtime s[6:7]
    s_waitcnt lgkmcnt(0)
    s_or_b32 s6, s6, 1
    v_mov_b32 v10, s6
    v_mov_b32 v11, s7
    s_mov_b64 exec, 1
    buffer_store_dwordx2 v[10:11], off, s[52:55], 0 sc1
    s_mov_b64 exec, -1
P1_ld_loop:
    s_lshl_b32 s6, s39, 7
    s_add_u32 s6, s6, s48
    s_mul_i32 s7, s39, 196608
    s_add_u32 m0, s50, 0
    s_add_u32 s32, s6, 0
    buffer_load_dwordx4 v6, s[12:15], s32 offen lds
    s_add_u32 m0, s50, 4096
    s_add_u32 s32, s6, 32768
    buffer_load_dwordx4 v6, s[12:15], s32 offen lds
    s_add_u32 m0, s50, 8192
    s_add_u32 s32, s6, 65536
    buffer_load_dwordx4 v6, s[12:15], s32 offen lds
    s_add_u32 m0, s50, 12288
    s_add_u32 s32, s6, 98304
    buffer_load_dwordx4 v6, s[12:15], s32 offen lds
    s_add_u32 m0, s31, 16384
    s_add_u32 s32, s49, s7
    buffer_load_dwordx4 v7, s[16:19], s32 offen lds
    s_add_u32 m0, s31, 17408
    s_add_u32 s32, s32, 24576
    buffer_load_dwordx4 v7, s[16:19], s32 offen lds
    s_add_u32 m0, s31, 24576
    s_add_u32 s32, s29, s7
    buffer_load_dwordx4 v7, s[20:23], s32 offen lds
    s_add_u32 m0, s31, 25600
    s_add_u32 s32, s32, 24576
    buffer_load_dwordx4 v7, s[20:23], s32 offen lds
    s_add_u32 m0, s31, 32768
    s_add_u32 s32, s30, s7
    buffer_load_dwordx4 v7, s[24:27], s32 offen lds
    s_add_u32 m0, s31, 33792
    s_add_u32 s32, s32, 24576
    buffer_load_dwordx4 v7, s[24:27], s32 offen lds
    s_add_u32 s39, s39, 1
    s_and_b32 s39, s39, 7
    s_add_u32 s50, s50, 40960
    s_add_u32 s31, s31, 40960
    s_cmp_lt_u32 s50, 122880
    s_cbranch_scc1 P1_ld_nowrap
    s_sub_u32 s50, s50, 122880
    s_sub_u32 s31, s31, 122880
P1_ld_nowrap:
    s_add_u32 s51, s51, 1
    s_cmp_eq_u32 s51, 1
    s_cbranch_scc1 P1_ld_loop
    s_waitcnt vmcnt(10)
    s_barrier
    s_cmp_lt_u32 s51, 8
    s_cbranch_scc1 P1_ld_loop
    s_mov_b32 s8, s60
    s_mov_b32 s9, s61
    s_mov_b32 s10, 18874368
    s_mov_b32 s11, 0x00020000
    s_waitcnt vmcnt(0)
    s_barrier
    s_cmp_lg_u32 s28, 3
    s_cbranch_scc1 P1_notag
    s_mov_b32 s3, 0
P1_tagpoll:
    buffer_load_dwordx2 v[10:11], off, s[52:55], 0 sc1
    s_add_u32 s3, s3, 1
    s_waitcnt vmcnt(0)
    v_cmp_eq_u32 vcc, 0, v10
    s_cmp_gt_u32 s3, 0x400000
    s_cbranch_scc1 P1_tagdone
    s_cbranch_vccnz P1_tagpoll
P1_tagdone:
    ds_write_b64 v2, v[10:11] offset:24
P1_notag:
    s_lshl_b32 s62, s37, 12
    s_lshl_b32 s3, s33, 8
    s_add_u32 s62, s62, s3
    s_lshl_b32 s3, s38, 7
    s_add_u32 s62, s62, s3
    s_add_u32 s62, s62, 17924096
    s_waitcnt lgkmcnt(0)
    s_barrier
    ds_read_b64 v[10:11], v2 offset:24
    s_setprio 3
    s_waitcnt lgkmcnt(0)
    v_readfirstlane_b32 s34, v10
    v_readfirstlane_b32 s35, v11
    s_lshl_b32 s3, s33, 7
    s_lshl_b32 s4, s36, 3
    s_add_u32 s33, s3, s4
    s_and_b32 s44, s2, 7
    s_lshl_b32 s44, s44, 2
    s_lshr_b32 s45, s2, 3
    s_and_b32 s3, s45, 3
    s_add_u32 s44, s44, s3
    s_lshl_b32 s46, s44, 3
    s_lshl_b32 s3, s28, 1
    s_add_u32 s46, s46, s3
    s_lshl_b32 s4, s46, 8
    s_add_u32 s4, s4, 10485760
    s_lshl_b32 s5, s46, 4
    s_add_u32 s5, s5, 11534336
    v_lshrrev_b32 v10, 5, v0
    v_and_b32 v11, 15, v0
    v_lshlrev_b32 v12, 7, v10
    v_lshlrev_b32 v11, 3, v11
    v_add3_u32 v12, v12, v11, s4
    v_lshlrev_b32 v10, 3, v10
    v_add_u32 v10, s5, v10
    v_and_b32 v11, 16, v0
    v_cmp_ne_u32 s[4:5], 0, v11
    v_mov_b32 v13, 256
    v_lshlrev_b32 v146, 5, v0
    v_cndmask_b32 v144, v12, v10, s[4:5]
    v_cndmask_b32 v13, v13, 16, s[4:5]
    v_add_u32 v145, v144, v13
    v_add_u32 v146, 133120, v146
    s_lshl_b32 s3, s28, 3
    v_add_u32 v147, s3, v146
    s_mul_i32 s46, s28, 6144
    s_add_u32 s46, s46, 139264
    v_lshrrev_b32 v10, 3, v0
    v_lshlrev_b32 v11, 10, v10
    v_and_b32 v12, 16, v0
    v_lshrrev_b32 v12, 2, v12
    v_and_b32 v13, 7, v0
    v_xor_b32 v12, v12, v13
    v_lshlrev_b32 v12, 4, v12
    v_add_u32 v148, v11, v12
    v_lshrrev_b32 v10, 5, v0
    v_lshlrev_b32 v10, 2, v10
    v_and_b32 v11, 15, v0
    v_lshrrev_b32 v11, 2, v11
    v_add_u32 v10, v10, v11
    v_lshlrev_b32 v10, 7, v10
    v_and_b32 v11, 8, v0
    v_lshlrev_b32 v11, 3, v11
    s_and_b32 s3, s28, 1
    s_lshl_b32 s3, s3, 6
    v_xor_b32 v11, s3, v11
    v_add_u32 v10, v10, v11
    v_and_b32 v11, 16, v0
    v_lshlrev_b32 v11, 1, v11
    v_add_u32 v10, v10, v11
    v_and_b32 v11, 3, v0
    v_lshlrev_b32 v11, 3, v11
    v_add_u32 v10, v10, v11
    v_xor_b32 v150, 64, v10
    v_add_u32 v149, s46, v10
    v_add_u32 v150, s46, v150
    s_lshr_b32 s3, s28, 1
    s_lshl_b32 s3, s3, 10
    v_add_u32 v152, s3, v1
    v_xor_b32 v153, 1024, v152
    v_subrev_u32 v156, s46, v149
    v_and_b32 v10, 31, v0
    s_lshl_b32 s3, s44, 6
    s_lshr_b32 s4, s28, 1
    s_lshl_b32 s5, s4, 5
    s_add_u32 s3, s3, s5
    v_add_u32 v10, s3, v10
    v_lshlrev_b32 v154, 2, v10
    v_add_u32 v154, 16777216, v154
    v_lshlrev_b32 v155, 10, v10
    v_lshrrev_b32 v10, 5, v0
    v_lshlrev_b32 v10, 4, v10
    v_add_u32 v155, v155, v10
    s_lshl_b32 s4, s4, 10
    s_add_u32 s4, s4, 65536
    v_add_u32 v157, s4, v1
    s_lshl_b32 s3, s28, 14
    v_add_u32 v158, s3, v1
    v_xor_b32 v159, 16384, v158
    v_xor_b32 v160, 32768, v158
    v_xor_b32 v161, 49152, v158
    s_mov_b32 s63, s38
    s_and_b32 s38, s2, 7
    s_lshl_b32 s13, s38, 2
    s_lshr_b32 s3, s2, 3
    s_and_b32 s36, s3, 3
    s_lshr_b32 s37, s3, 2
    s_add_u32 s13, s13, s36
    s_mov_b32 s36, s13
    s_lshr_b32 s14, s2, 5
    s_cmp_lg_u32 s28, 2
    s_cbranch_scc1 H_nf1
    s_lshl_b32 s19, s38, 12
    s_add_u32 s19, s19, 17891328
Lp1:
    ds_read_b32 v3, v2 offset:32
    s_waitcnt lgkmcnt(0)
    v_readfirstlane_b32 s3, v3
    s_cmp_ge_u32 s3, 4
    s_cbranch_scc1 Lq2
    s_sleep 2
    s_branch Lp1
Lq2:
    v_lshlrev_b32 v12, 7, v0
    s_mov_b32 s3, 0
    s_mov_b64 exec, 0xffffffff
Lf3:
    buffer_load_dwordx2 v[10:11], v12, s[8:11], s19 offen sc1
    s_waitcnt vmcnt(0)
    v_cmp_ne_u64 vcc, s[34:35], v[10:11]
    s_add_u32 s3, s3, 1
    s_cmp_gt_u32 s3, 0x200000
    s_cbranch_scc1 Lg4
    s_cbranch_vccz Lg4
    s_mov_b64 exec, vcc
    s_sleep 2
    s_branch Lf3
Lg4:
    s_mov_b64 exec, -1
    v_mov_b32 v3, 1
    s_mov_b64 exec, 1
    ds_add_u32 v2, v3 offset:48
    s_mov_b64 exec, -1
H_nf1:
    s_cmp_lg_u32 s28, 3
    s_cbranch_scc1 H_nfq
    s_lshl_b32 s19, s38, 11
    s_lshl_b32 s3, s14, 8
    s_add_u32 s19, s19, s3
    s_add_u32 s19, s19, 17956864
Lp5:
    ds_read_b32 v3, v2 offset:32
    s_waitcnt lgkmcnt(0)
    v_readfirstlane_b32 s3, v3
    s_cmp_ge_u32 s3, 4
    s_cbranch_scc1 Lq6
    s_sleep 2
    s_branch Lp5
Lq6:
    v_lshlrev_b32 v12, 7, v0
    s_mov_b32 s3, 0
    s_mov_b64 exec, 0x3
Lf7:
    buffer_load_dwordx2 v[10:11], v12, s[8:11], s19 offen sc1
    s_waitcnt vmcnt(0)
    v_cmp_ne_u64 vcc, s[34:35], v[10:11]
    s_add_u32 s3, s3, 1
    s_cmp_gt_u32 s3, 0x200000
    s_cbranch_scc1 Lg8
    s_cbranch_vccz Lg8
    s_mov_b64 exec, vcc
    s_sleep 4
    s_branch Lf7
Lg8:
    s_mov_b64 exec, -1
    v_mov_b32 v3, 1
    s_mov_b64 exec, 1
    ds_add_u32 v2, v3 offset:72
    s_mov_b64 exec, -1
H_nfq:
Lp9:
    ds_read_b32 v3, v2 offset:48
    s_waitcnt lgkmcnt(0)
    v_readfirstlane_b32 s3, v3
    s_cmp_ge_u32 s3, 1
    s_cbranch_scc1 Lq10
    s_sleep 2
    s_branch Lp9
Lq10:
    s_lshl_b32 s18, s28, 10
    s_lshl_b32 s17, s13, 17
    s_add_u32 s17, s17, 2097152
    s_add_u32 s17, s17, s18
    v_add_u32 v4, s18, v1
    s_add_u32 s19, s17, 0
    buffer_load_dwordx4 v[16:19], v1, s[8:11], s19 offen sc1
    s_add_u32 s19, s17, 4096
    buffer_load_dwordx4 v[20:23], v1, s[8:11], s19 offen sc1
    s_add_u32 s19, s17, 8192
    buffer_load_dwordx4 v[24:27], v1, s[8:11], s19 offen sc1
    s_add_u32 s19, s17, 12288
    buffer_load_dwordx4 v[28:31], v1, s[8:11], s19 offen sc1
    s_add_u32 s19, s17, 16384
    buffer_load_dwordx4 v[32:35], v1, s[8:11], s19 offen sc1
    s_add_u32 s19, s17, 20480
    buffer_load_dwordx4 v[36:39], v1, s[8:11], s19 offen sc1
    s_add_u32 s19, s17, 24576
    buffer_load_dwordx4 v[40:43], v1, s[8:11], s19 offen sc1
    s_add_u32 s19, s17, 28672
    buffer_load_dwordx4 v[44:47], v1, s[8:11], s19 offen sc1
    s_add_u32 s17, s17, 32768
    s_waitcnt vmcnt(7)
    ds_write_b128 v4, v[16:19] offset:0
    s_waitcnt vmcnt(6)
    ds_write_b128 v4, v[20:23] offset:4096
    s_waitcnt vmcnt(5)
    ds_write_b128 v4, v[24:27] offset:8192
    s_waitcnt vmcnt(4)
    ds_write_b128 v4, v[28:31] offset:12288
    s_waitcnt vmcnt(3)
    ds_write_b128 v4, v[32:35] offset:16384
    s_waitcnt lgkmcnt(0)
    v_mov_b32 v3, 1
    s_mov_b64 exec, 1
    ds_add_u32 v2, v3 offset:52
    s_mov_b64 exec, -1
    s_waitcnt vmcnt(2)
    ds_write_b128 v4, v[36:39] offset:20480
    s_waitcnt vmcnt(1)
    ds_write_b128 v4, v[40:43] offset:24576
    s_waitcnt vmcnt(0)
    ds_write_b128 v4, v[44:47] offset:28672
    v_add_u32 v4, 32768, v4
    s_waitcnt lgkmcnt(0)
    s_add_u32 s19, s17, 0
    buffer_load_dwordx4 v[48:51], v1, s[8:11], s19 offen sc1
    s_add_u32 s19, s17, 4096
    buffer_load_dwordx4 v[52:55], v1, s[8:11], s19 offen sc1
    s_add_u32 s19, s17, 8192
    buffer_load_dwordx4 v[56:59], v1, s[8:11], s19 offen sc1
    s_add_u32 s19, s17, 12288
    buffer_load_dwordx4 v[60:63], v1, s[8:11], s19 offen sc1
    s_add_u32 s19, s17, 16384
    buffer_load_dwordx4 v[64:67], v1, s[8:11], s19 offen sc1
    s_add_u32 s19, s17, 20480
    buffer_load_dwordx4 v[68:71], v1, s[8:11], s19 offen sc1
    s_add_u32 s19, s17, 24576
    buffer_load_dwordx4 v[72:75], v1, s[8:11], s19 offen sc1
    s_add_u32 s19, s17, 28672
    buffer_load_dwordx4 v[76:79], v1, s[8:11], s19 offen sc1
    s_add_u32 s17, s17, 32768
    s_add_u32 s19, s17, 0
    buffer_load_dwordx4 v[16:19], v1, s[8:11], s19 offen sc1
    s_add_u32 s19, s17, 4096
    buffer_load_dwordx4 v[20:23], v1, s[8:11], s19 offen sc1
    s_add_u32 s19, s17, 8192
    buffer_load_dwordx4 v[24:27], v1, s[8:11], s19 offen sc1
    s_add_u32 s19, s17, 12288
    buffer_load_dwordx4 v[28:31], v1, s[8:11], s19 offen sc1
    s_add_u32 s19, s17, 16384
    buffer_load_dwordx4 v[32:35], v1, s[8:11], s19 offen sc1
    s_add_u32 s19, s17, 20480
    buffer_load_dwordx4 v[36:39], v1, s[8:11], s19 offen sc1
    s_add_u32 s19, s17, 24576
    buffer_load_dwordx4 v[40:43], v1, s[8:11], s19 offen sc1
    s_add_u32 s19, s17, 28672
    buffer_load_dwordx4 v[44:47], v1, s[8:11], s19 offen sc1
    s_add_u32 s17, s17, 32768
    s_waitcnt vmcnt(15)
    ds_write_b128 v4, v[48:51] offset:0
    s_waitcnt vmcnt(14)
    ds_write_b128 v4, v[52:55] offset:4096
    s_waitcnt vmcnt(13)
    ds_write_b128 v4, v[56:59] offset:8192
    s_waitcnt vmcnt(12)
    ds_write_b128 v4, v[60:63] offset:12288
    s_waitcnt vmcnt(11)
    ds_write_b128 v4, v[64:67] offset:16384
    s_waitcnt vmcnt(10)
    ds_write_b128 v4, v[68:71] offset:20480
    s_waitcnt vmcnt(9)
    ds_write_b128 v4, v[72:75] offset:24576
    s_waitcnt vmcnt(8)
    ds_write_b128 v4, v[76:79] offset:28672
    v_add_u32 v4, 32768, v4
    s_waitcnt lgkmcnt(0)
    v_mov_b32 v3, 1
    s_mov_b64 exec, 1
    ds_add_u32 v2, v3 offset:56
    s_mov_b64 exec, -1
    s_add_u32 s19, s17, 0
    buffer_load_dwordx4 v[48:51], v1, s[8:11], s19 offen sc1
    s_add_u32 s19, s17, 4096
    buffer_load_dwordx4 v[52:55], v1, s[8:11], s19 offen sc1
    s_add_u32 s19, s17, 8192
    buffer_load_dwordx4 v[56:59], v1, s[8:11], s19 offen sc1
    s_add_u32 s19, s17, 12288
    buffer_load_dwordx4 v[60:63], v1, s[8:11], s19 offen sc1
    s_add_u32 s19, s17, 16384
    buffer_load_dwordx4 v[64:67], v1, s[8:11], s19 offen sc1
    s_add_u32 s19, s17, 20480
    buffer_load_dwordx4 v[68:71], v1, s[8:11], s19 offen sc1
    s_add_u32 s19, s17, 24576
    buffer_load_dwordx4 v[72:75], v1, s[8:11], s19 offen sc1
    s_add_u32 s19, s17, 28672
    buffer_load_dwordx4 v[76:79], v1, s[8:11], s19 offen sc1
    s_add_u32 s17, s17, 32768
    s_cmp_lg_u32 s63, 0
    s_cbranch_scc1 H_nored
Lp11:
    ds_read_b32 v3, v2 offset:44
    s_waitcnt lgkmcnt(0)
    v_readfirstlane_b32 s3, v3
    s_cmp_ge_u32 s3, 8
    s_cbranch_scc1 Lq12
    s_sleep 1
    s_branch Lp11
Lq12:
H_nored:
    s_waitcnt vmcnt(15)
    ds_write_b128 v4, v[16:19] offset:0
    s_waitcnt vmcnt(14)
    ds_write_b128 v4, v[20:23] offset:4096
    s_waitcnt vmcnt(13)
    ds_write_b128 v4, v[24:27] offset:8192
    s_waitcnt vmcnt(12)
    ds_write_b128 v4, v[28:31] offset:12288
    s_waitcnt vmcnt(11)
    ds_write_b128 v4, v[32:35] offset:16384
    s_waitcnt vmcnt(10)
    ds_write_b128 v4, v[36:39] offset:20480
    s_waitcnt vmcnt(9)
    ds_write_b128 v4, v[40:43] offset:24576
    s_waitcnt vmcnt(8)
    ds_write_b128 v4, v[44:47] offset:28672
    v_add_u32 v4, 32768, v4
    s_waitcnt lgkmcnt(0)
    s_waitcnt vmcnt(7)
    ds_write_b128 v4, v[48:51] offset:0
    s_waitcnt vmcnt(6)
    ds_write_b128 v4, v[52:55] offset:4096
    s_waitcnt vmcnt(5)
    ds_write_b128 v4, v[56:59] offset:8192
    s_waitcnt vmcnt(4)
    ds_write_b128 v4, v[60:63] offset:12288
    s_waitcnt vmcnt(3)
    ds_write_b128 v4, v[64:67] offset:16384
    s_waitcnt vmcnt(2)
    ds_write_b128 v4, v[68:71] offset:20480
    s_waitcnt vmcnt(1)
    ds_write_b128 v4, v[72:75] offset:24576
    s_waitcnt vmcnt(0)
    ds_write_b128 v4, v[76:79] offset:28672
    v_add_u32 v4, 32768, v4
    s_waitcnt lgkmcnt(0)
    v_mov_b32 v3, 1
    s_mov_b64 exec, 1
    ds_add_u32 v2, v3 offset:76
    s_mov_b64 exec, -1
    s_setprio 3
    s_mov_b32 s40, s70
    s_mov_b32 s41, s71
    s_mov_b32 s42, 524288
    s_mov_b32 s43, 0x00020000
    s_mov_b32 s44, s76
    s_mov_b32 s45, s77
    s_mov_b32 s46, 524288
    s_mov_b32 s47, 0x00020000
    s_lshr_b32 s3, s2, 3
    s_lshl_b32 s3, s3, 2
    s_add_u32 s3, s3, s28
    s_lshl_b32 s3, s3, 12
    buffer_load_dwordx4 v[112:115], v1, s[40:43], s3 offen offset:0
    buffer_load_dwordx4 v[116:119], v1, s[44:47], s3 offen offset:0
    buffer_load_dwordx4 v[120:123], v1, s[40:43], s3 offen offset:1024
    buffer_load_dwordx4 v[124:127], v1, s[44:47], s3 offen offset:1024
    buffer_load_dwordx4 v[128:131], v1, s[40:43], s3 offen offset:2048
    buffer_load_dwordx4 v[132:135], v1, s[44:47], s3 offen offset:2048
    buffer_load_dwordx4 v[136:139], v1, s[40:43], s3 offen offset:3072
    buffer_load_dwordx4 v[140:143], v1, s[44:47], s3 offen offset:3072
    s_cmp_lg_u32 s28, 0
    s_cbranch_scc1 H_nogate
    s_mov_b32 s44, s78
    s_mov_b32 s45, s79
    s_mov_b32 s46, 1024
    s_mov_b32 s47, 0x00020000
    s_mov_b32 s24, s64
    s_mov_b32 s25, s65
    s_mov_b32 s26, 2097152
    s_mov_b32 s27, 0x00020000
    v_lshrrev_b32 v8, 3, v0
    v_add_u32 v8, s33, v8
    v_and_b32 v3, 7, v0
    v_lshlrev_b32 v3, 4, v3
    v_lshlrev_b32 v4, 10, v8
    v_add_u32 v4, v4, v3
    buffer_load_dwordx4 v[16:19], v4, s[24:27], 0 offen offset:0
    buffer_load_dwordx4 v[48:51], v3, s[44:47], 0 offen offset:0
    buffer_load_dwordx4 v[20:23], v4, s[24:27], 0 offen offset:128
    buffer_load_dwordx4 v[52:55], v3, s[44:47], 0 offen offset:128
    buffer_load_dwordx4 v[24:27], v4, s[24:27], 0 offen offset:256
    buffer_load_dwordx4 v[56:59], v3, s[44:47], 0 offen offset:256
    buffer_load_dwordx4 v[28:31], v4, s[24:27], 0 offen offset:384
    buffer_load_dwordx4 v[60:63], v3, s[44:47], 0 offen offset:384
    buffer_load_dwordx4 v[32:35], v4, s[24:27], 0 offen offset:512
    buffer_load_dwordx4 v[64:67], v3, s[44:47], 0 offen offset:512
    buffer_load_dwordx4 v[36:39], v4, s[24:27], 0 offen offset:640
    buffer_load_dwordx4 v[68:71], v3, s[44:47], 0 offen offset:640
    buffer_load_dwordx4 v[40:43], v4, s[24:27], 0 offen offset:768
    buffer_load_dwordx4 v[72:75], v3, s[44:47], 0 offen offset:768
    buffer_load_dwordx4 v[44:47], v4, s[24:27], 0 offen offset:896
    buffer_load_dwordx4 v[76:79], v3, s[44:47], 0 offen offset:896
    v_mov_b32 v5, 0
    v_mov_b32 v6, 0
    s_waitcnt vmcnt(0)
    v_dot2_f32_bf16 v5, v16, v48, v5
    v_dot2_f32_bf16 v6, v17, v49, v6
    v_dot2_f32_bf16 v5, v18, v50, v5
    v_dot2_f32_bf16 v6, v19, v51, v6
    v_dot2_f32_bf16 v5, v20, v52, v5
    v_dot2_f32_bf16 v6, v21, v53, v6
    v_dot2_f32_bf16 v5, v22, v54, v5
    v_dot2_f32_bf16 v6, v23, v55, v6
    v_dot2_f32_bf16 v5, v24, v56, v5
    v_dot2_f32_bf16 v6, v25, v57, v6
    v_dot2_f32_bf16 v5, v26, v58, v5
    v_dot2_f32_bf16 v6, v27, v59, v6
    v_dot2_f32_bf16 v5, v28, v60, v5
    v_dot2_f32_bf16 v6, v29, v61, v6
    v_dot2_f32_bf16 v5, v30, v62, v5
    v_dot2_f32_bf16 v6, v31, v63, v6
    v_dot2_f32_bf16 v5, v32, v64, v5
    v_dot2_f32_bf16 v6, v33, v65, v6
    v_dot2_f32_bf16 v5, v34, v66, v5
    v_dot2_f32_bf16 v6, v35, v67, v6
    v_dot2_f32_bf16 v5, v36, v68, v5
    v_dot2_f32_bf16 v6, v37, v69, v6
    v_dot2_f32_bf16 v5, v38, v70, v5
    v_dot2_f32_bf16 v6, v39, v71, v6
    v_dot2_f32_bf16 v5, v40, v72, v5
    v_dot2_f32_bf16 v6, v41, v73, v6
    v_dot2_f32_bf16 v5, v42, v74, v5
    v_dot2_f32_bf16 v6, v43, v75, v6
    v_dot2_f32_bf16 v5, v44, v76, v5
    v_dot2_f32_bf16 v6, v45, v77, v6
    v_dot2_f32_bf16 v5, v46, v78, v5
    v_dot2_f32_bf16 v6, v47, v79, v6
    s_nop 3
    v_add_f32 v5, v5, v6
    ds_swizzle_b32 v6, v5 offset:1055
    s_waitcnt lgkmcnt(0)
    v_add_f32 v5, v5, v6
    ds_swizzle_b32 v6, v5 offset:2079
    s_waitcnt lgkmcnt(0)
    v_add_f32 v5, v5, v6
    ds_swizzle_b32 v6, v5 offset:4127
    s_waitcnt lgkmcnt(0)
    v_add_f32 v5, v5, v6
    v_cvt_pk_bf16_f32 v5, v5, v5
    v_lshlrev_b32 v5, 16, v5
    v_mul_f32 v5, 0xbfb8aa3b, v5
    v_exp_f32 v5, v5
    s_nop 0
    v_add_f32 v5, 1.0, v5
    v_rcp_f32 v5, v5
    s_nop 0
    v_cvt_pk_bf16_f32 v5, v5, v5
    v_lshlrev_b32 v5, 16, v5
    v_lshlrev_b32 v8, 2, v8
    v_add_u32 v8, 16777216, v8
    buffer_store_dword v5, v8, s[8:11], 0 offen sc1
    s_waitcnt vmcnt(0)
    v_mov_b32 v3, 1
    s_mov_b64 exec, 1
    ds_add_rtn_u32 v3, v2, v3 offset:36
    s_waitcnt lgkmcnt(0)
    v_readfirstlane_b32 s3, v3
    s_mov_b64 exec, -1
    s_cmp_lg_u32 s3, 8
    s_cbranch_scc1 H_nogate
    v_mov_b32 v10, s34
    v_mov_b32 v11, s35
    v_mov_b32 v12, 0
    s_mov_b64 exec, 1
    buffer_store_dwordx2 v[10:11], v12, s[8:11], s62 offen sc1
    s_mov_b64 exec, -1
H_nogate:
    s_lshl_b32 s21, s28, 1
    s_cmp_lg_u32 s28, 0
    s_cbranch_scc1 H_nf2
    s_lshl_b32 s19, s38, 12
    s_add_u32 s19, s19, 17924096
Lp13:
    ds_read_b32 v3, v2 offset:36
    s_waitcnt lgkmcnt(0)
    v_readfirstlane_b32 s3, v3
    s_cmp_ge_u32 s3, 9
    s_cbranch_scc1 Lq14
    s_sleep 8
    s_branch Lp13
Lq14:
    v_lshlrev_b32 v12, 7, v0
    s_mov_b32 s3, 0
    s_mov_b64 exec, 0xffffffff
Lf15:
    buffer_load_dwordx2 v[10:11], v12, s[8:11], s19 offen sc1
    s_waitcnt vmcnt(0)
    v_cmp_ne_u64 vcc, s[34:35], v[10:11]
    s_add_u32 s3, s3, 1
    s_cmp_gt_u32 s3, 0x200000
    s_cbranch_scc1 Lg16
    s_cbranch_vccz Lg16
    s_mov_b64 exec, vcc
    s_sleep 8
    s_branch Lf15
Lg16:
    s_mov_b64 exec, -1
    v_mov_b32 v3, 1
    s_mov_b64 exec, 1
    ds_add_u32 v2, v3 offset:60
    s_mov_b64 exec, -1
H_nf2:
Lp17:
    ds_read_b32 v3, v2 offset:60
    s_waitcnt lgkmcnt(0)
    v_readfirstlane_b32 s3, v3
    s_cmp_ge_u32 s3, 1
    s_cbranch_scc1 Lq18
    s_sleep 8
    s_branch Lp17
Lq18:
HM_f2:
    s_mov_b32 s3, 0
    buffer_load_dwordx2 v[16:17], v144, s[8:11], s3 offen sc1
    buffer_load_dwordx2 v[48:49], v145, s[8:11], s3 offen sc1
    s_mov_b32 s3, 65536
    buffer_load_dwordx2 v[18:19], v144, s[8:11], s3 offen sc1
    buffer_load_dwordx2 v[50:51], v145, s[8:11], s3 offen sc1
    s_mov_b32 s3, 131072
    buffer_load_dwordx2 v[20:21], v144, s[8:11], s3 offen sc1
    buffer_load_dwordx2 v[52:53], v145, s[8:11], s3 offen sc1
    s_mov_b32 s3, 196608
    buffer_load_dwordx2 v[22:23], v144, s[8:11], s3 offen sc1
    buffer_load_dwordx2 v[54:55], v145, s[8:11], s3 offen sc1
    s_mov_b32 s3, 262144
    buffer_load_dwordx2 v[24:25], v144, s[8:11], s3 offen sc1
    buffer_load_dwordx2 v[56:57], v145, s[8:11], s3 offen sc1
    s_mov_b32 s3, 327680
    buffer_load_dwordx2 v[26:27], v144, s[8:11], s3 offen sc1
    buffer_load_dwordx2 v[58:59], v145, s[8:11], s3 offen sc1
    s_mov_b32 s3, 393216
    buffer_load_dwordx2 v[28:29], v144, s[8:11], s3 offen sc1
    buffer_load_dwordx2 v[60:61], v145, s[8:11], s3 offen sc1
    s_mov_b32 s3, 458752
    buffer_load_dwordx2 v[30:31], v144, s[8:11], s3 offen sc1
    buffer_load_dwordx2 v[62:63], v145, s[8:11], s3 offen sc1
    s_mov_b32 s3, 524288
    buffer_load_dwordx2 v[32:33], v144, s[8:11], s3 offen sc1
    buffer_load_dwordx2 v[64:65], v145, s[8:11], s3 offen sc1
    s_mov_b32 s3, 589824
    buffer_load_dwordx2 v[34:35], v144, s[8:11], s3 offen sc1
    buffer_load_dwordx2 v[66:67], v145, s[8:11], s3 offen sc1
    s_mov_b32 s3, 655360
    buffer_load_dwordx2 v[36:37], v144, s[8:11], s3 offen sc1
    buffer_load_dwordx2 v[68:69], v145, s[8:11], s3 offen sc1
    s_mov_b32 s3, 720896
    buffer_load_dwordx2 v[38:39], v144, s[8:11], s3 offen sc1
    buffer_load_dwordx2 v[70:71], v145, s[8:11], s3 offen sc1
    s_mov_b32 s3, 786432
    buffer_load_dwordx2 v[40:41], v144, s[8:11], s3 offen sc1
    buffer_load_dwordx2 v[72:73], v145, s[8:11], s3 offen sc1
    s_mov_b32 s3, 851968
    buffer_load_dwordx2 v[42:43], v144, s[8:11], s3 offen sc1
    buffer_load_dwordx2 v[74:75], v145, s[8:11], s3 offen sc1
    s_mov_b32 s3, 917504
    buffer_load_dwordx2 v[44:45], v144, s[8:11], s3 offen sc1
    buffer_load_dwordx2 v[76:77], v145, s[8:11], s3 offen sc1
    s_mov_b32 s3, 983040
    buffer_load_dwordx2 v[46:47], v144, s[8:11], s3 offen sc1
    buffer_load_dwordx2 v[78:79], v145, s[8:11], s3 offen sc1
    s_lshl_b32 s15, s14, 3
    s_add_u32 s15, s15, s21
    s_lshl_b32 s16, s13, 6
    s_add_u32 s16, s16, s15
    s_lshl_b32 s19, s16, 11
    s_add_u32 s19, s19, 6291456
    buffer_load_dwordx4 v[80:83], v1, s[8:11], s19 offen offset:0 sc1
    buffer_load_dwordx4 v[84:87], v1, s[8:11], s19 offen offset:1024 sc1
    buffer_load_dwordx4 v[88:91], v1, s[8:11], s19 offen offset:2048 sc1
    buffer_load_dwordx4 v[92:95], v1, s[8:11], s19 offen offset:3072 sc1
    s_waitcnt vmcnt(4)
    v_pk_add_f32 v[16:17], v[16:17], v[32:33]
    v_pk_add_f32 v[48:49], v[48:49], v[64:65]
    v_pk_add_f32 v[18:19], v[18:19], v[34:35]
    v_pk_add_f32 v[50:51], v[50:51], v[66:67]
    v_pk_add_f32 v[20:21], v[20:21], v[36:37]
    v_pk_add_f32 v[52:53], v[52:53], v[68:69]
    v_pk_add_f32 v[22:23], v[22:23], v[38:39]
    v_pk_add_f32 v[54:55], v[54:55], v[70:71]
    v_pk_add_f32 v[24:25], v[24:25], v[40:41]
    v_pk_add_f32 v[56:57], v[56:57], v[72:73]
    v_pk_add_f32 v[26:27], v[26:27], v[42:43]
    v_pk_add_f32 v[58:59], v[58:59], v[74:75]
    v_pk_add_f32 v[28:29], v[28:29], v[44:45]
    v_pk_add_f32 v[60:61], v[60:61], v[76:77]
    v_pk_add_f32 v[30:31], v[30:31], v[46:47]
    v_pk_add_f32 v[62:63], v[62:63], v[78:79]
    v_pk_add_f32 v[16:17], v[16:17], v[24:25]
    v_pk_add_f32 v[48:49], v[48:49], v[56:57]
    v_pk_add_f32 v[18:19], v[18:19], v[26:27]
    v_pk_add_f32 v[50:51], v[50:51], v[58:59]
    v_pk_add_f32 v[20:21], v[20:21], v[28:29]
    v_pk_add_f32 v[52:53], v[52:53], v[60:61]
    v_pk_add_f32 v[22:23], v[22:23], v[30:31]
    v_pk_add_f32 v[54:55], v[54:55], v[62:63]
    v_pk_add_f32 v[16:17], v[16:17], v[20:21]
    v_pk_add_f32 v[48:49], v[48:49], v[52:53]
    v_pk_add_f32 v[18:19], v[18:19], v[22:23]
    v_pk_add_f32 v[50:51], v[50:51], v[54:55]
    v_pk_add_f32 v[16:17], v[16:17], v[18:19]
    v_pk_add_f32 v[48:49], v[48:49], v[50:51]
    v_cvt_pk_bf16_f32 v16, v16, v17
    v_cvt_pk_bf16_f32 v17, v48, v49
    ds_write_b64 v147, v[16:17]
    s_waitcnt lgkmcnt(0)
    v_mov_b32 v3, 1
    s_mov_b64 exec, 1
    ds_add_u32 v2, v3 offset:0
    s_mov_b64 exec, -1
Lp19:
    ds_read_b32 v3, v2 offset:0
    s_waitcnt lgkmcnt(0)
    v_readfirstlane_b32 s3, v3
    s_cmp_ge_u32 s3, 4
    s_cbranch_scc1 Lq20
    s_sleep 1
    s_branch Lp19
Lq20:
    ds_read_b128 v[16:19], v146
    ds_read_b128 v[20:23], v146 offset:16
    s_waitcnt vmcnt(0) lgkmcnt(0)
    v_mfma_f32_32x32x16_bf16 v[32:47], v[16:19], v[80:83], 0
    v_mfma_f32_32x32x16_bf16 v[32:47], v[20:23], v[84:87], v[32:47]
    v_mfma_f32_32x32x16_bf16 v[48:63], v[16:19], v[88:91], 0
    v_mfma_f32_32x32x16_bf16 v[48:63], v[20:23], v[92:95], v[48:63]
    s_lshl_b32 s20, s16, 10
    s_add_u32 s20, s20, 12582912
    s_mov_b32 s40, s70
    s_mov_b32 s41, s71
    s_mov_b32 s42, 524288
    s_mov_b32 s43, 0x00020000
    s_nop 5
    v_add_f32 v10, 0x358637bd, v40
    v_add_f32 v12, 0x358637bd, v56
    v_rcp_f32 v10, v10
    v_rcp_f32 v12, v12
    s_nop 0
    v_pk_mul_f32 v[32:33], v[32:33], v[10:11] op_sel_hi:[1,0]
    v_pk_mul_f32 v[34:35], v[34:35], v[10:11] op_sel_hi:[1,0]
    v_pk_mul_f32 v[36:37], v[36:37], v[10:11] op_sel_hi:[1,0]
    v_pk_mul_f32 v[38:39], v[38:39], v[10:11] op_sel_hi:[1,0]
    v_pk_mul_f32 v[48:49], v[48:49], v[12:13] op_sel_hi:[1,0]
    v_pk_mul_f32 v[50:51], v[50:51], v[12:13] op_sel_hi:[1,0]
    v_pk_mul_f32 v[52:53], v[52:53], v[12:13] op_sel_hi:[1,0]
    v_pk_mul_f32 v[54:55], v[54:55], v[12:13] op_sel_hi:[1,0]
    v_cvt_pk_bf16_f32 v64, v32, v33
    v_cvt_pk_bf16_f32 v65, v34, v35
    v_cvt_pk_bf16_f32 v66, v36, v37
    v_cvt_pk_bf16_f32 v67, v38, v39
    buffer_store_dwordx4 v[64:67], v1, s[8:11], s20 offen offset:0 sc1
    v_cvt_pk_bf16_f32 v68, v48, v49
    v_cvt_pk_bf16_f32 v69, v50, v51
    v_cvt_pk_bf16_f32 v70, v52, v53
    v_cvt_pk_bf16_f32 v71, v54, v55
    buffer_store_dwordx4 v[68:71], v1, s[8:11], s20 offen offset:1024 sc1
    s_mul_i32 s21, s28, 6144
    s_add_u32 s21, s21, 139264
    s_lshl_b32 s22, s28, 17
    s_lshl_b32 s3, s37, 7
    s_add_u32 s22, s22, s3
    s_lshl_b32 s23, s28, 19
    s_lshl_b32 s3, s36, 11
    s_add_u32 s23, s23, s3
    s_add_u32 s23, s23, 12582912
    s_waitcnt vmcnt(0)
    v_mov_b32 v3, 1
    s_mov_b64 exec, 1
    ds_add_rtn_u32 v3, v2, v3 offset:4
    s_waitcnt lgkmcnt(0)
    v_readfirstlane_b32 s3, v3
    s_mov_b64 exec, -1
    s_cmp_lg_u32 s3, 3
    s_cbranch_scc1 H_h1
    s_lshl_b32 s19, s14, 12
    s_lshl_b32 s3, s13, 7
    s_add_u32 s19, s19, s3
    s_add_u32 s19, s19, 17825792
    v_mov_b32 v10, s34
    v_mov_b32 v11, s35
    v_mov_b32 v12, 0
    s_mov_b64 exec, 1
    buffer_store_dwordx2 v[10:11], v12, s[8:11], s19 offen sc1
    s_mov_b64 exec, -1
H_h1:
    s_cmp_lg_u32 s28, 0
    s_cbranch_scc1 H_h2
    s_lshl_b32 s19, s38, 12
    s_add_u32 s19, s19, 17825792
    v_lshlrev_b32 v12, 7, v0
    s_mov_b32 s3, 0
    s_mov_b64 exec, 0xffffffff
Lf21:
    buffer_load_dwordx2 v[10:11], v12, s[8:11], s19 offen sc1
    s_waitcnt vmcnt(0)
    v_cmp_ne_u64 vcc, s[34:35], v[10:11]
    s_add_u32 s3, s3, 1
    s_cmp_gt_u32 s3, 0x200000
    s_cbranch_scc1 Lg22
    s_cbranch_vccz Lg22
    s_mov_b64 exec, vcc
    s_sleep 8
    s_branch Lf21
Lg22:
    s_mov_b64 exec, -1
    v_mov_b32 v3, 1
    s_mov_b64 exec, 1
    ds_add_u32 v2, v3 offset:8
    s_mov_b64 exec, -1
H_h2:
Lp23:
    ds_read_b32 v3, v2 offset:8
    s_waitcnt lgkmcnt(0)
    v_readfirstlane_b32 s3, v3
    s_cmp_ge_u32 s3, 1
    s_cbranch_scc1 Lq24
    s_sleep 8
    s_branch Lp23
Lq24:
HM_3a:
    buffer_load_dword v14, v154, s[8:11], 0 offen sc1
    s_add_u32 m0, s21, 0
    s_add_u32 s3, s22, 0
    buffer_load_dwordx4 v148, s[40:43], s3 offen lds
    s_add_u32 m0, s21, 1024
    s_add_u32 s3, s22, 8192
    buffer_load_dwordx4 v148, s[40:43], s3 offen lds
    s_add_u32 s3, s23, 0
    buffer_load_dwordx4 v[80:83], v152, s[8:11], s3 offen sc1
    buffer_load_dwordx4 v[84:87], v153, s[8:11], s3 offen sc1
    s_add_u32 m0, s21, 2048
    s_add_u32 s3, s22, 16384
    buffer_load_dwordx4 v148, s[40:43], s3 offen lds
    s_add_u32 m0, s21, 3072
    s_add_u32 s3, s22, 24576
    buffer_load_dwordx4 v148, s[40:43], s3 offen lds
    s_add_u32 s3, s23, 65536
    buffer_load_dwordx4 v[88:91], v152, s[8:11], s3 offen sc1
    buffer_load_dwordx4 v[92:95], v153, s[8:11], s3 offen sc1
    s_add_u32 m0, s21, 4096
    s_add_u32 s3, s22, 32768
    buffer_load_dwordx4 v148, s[40:43], s3 offen lds
    s_add_u32 m0, s21, 5120
    s_add_u32 s3, s22, 40960
    buffer_load_dwordx4 v148, s[40:43], s3 offen lds
    s_add_u32 s3, s23, 131072
    buffer_load_dwordx4 v[96:99], v152, s[8:11], s3 offen sc1
    buffer_load_dwordx4 v[100:103], v153, s[8:11], s3 offen sc1
    s_waitcnt vmcnt(8)
    ds_read_b64_tr_b16 v[104:105], v149 offset:0
    ds_read_b64_tr_b16 v[106:107], v149 offset:1024
    ds_read_b64_tr_b16 v[108:109], v150 offset:0
    ds_read_b64_tr_b16 v[110:111], v150 offset:1024
    s_waitcnt lgkmcnt(0)
    v_mfma_f32_32x32x16_bf16 v[16:31], v[104:107], v[80:83], 0
    v_mfma_f32_32x32x16_bf16 v[48:63], v[104:107], v[84:87], 0
    v_mfma_f32_32x32x16_bf16 v[32:47], v[108:111], v[80:83], 0
    v_mfma_f32_32x32x16_bf16 v[64:79], v[108:111], v[84:87], 0
    s_add_u32 m0, s21, 0
    s_add_u32 s3, s22, 49152
    buffer_load_dwordx4 v148, s[40:43], s3 offen lds
    s_add_u32 m0, s21, 1024
    s_add_u32 s3, s22, 57344
    buffer_load_dwordx4 v148, s[40:43], s3 offen lds
    s_add_u32 s3, s23, 196608
    buffer_load_dwordx4 v[80:83], v152, s[8:11], s3 offen sc1
    buffer_load_dwordx4 v[84:87], v153, s[8:11], s3 offen sc1
    s_waitcnt vmcnt(8)
    ds_read_b64_tr_b16 v[104:105], v149 offset:2048
    ds_read_b64_tr_b16 v[106:107], v149 offset:3072
    ds_read_b64_tr_b16 v[108:109], v150 offset:2048
    ds_read_b64_tr_b16 v[110:111], v150 offset:3072
    s_waitcnt lgkmcnt(0)
    v_mfma_f32_32x32x16_bf16 v[16:31], v[104:107], v[88:91], v[16:31]
    v_mfma_f32_32x32x16_bf16 v[48:63], v[104:107], v[92:95], v[48:63]
    v_mfma_f32_32x32x16_bf16 v[32:47], v[108:111], v[88:91], v[32:47]
    v_mfma_f32_32x32x16_bf16 v[64:79], v[108:111], v[92:95], v[64:79]
    s_add_u32 m0, s21, 2048
    s_add_u32 s3, s22, 65536
    buffer_load_dwordx4 v148, s[40:43], s3 offen lds
    s_add_u32 m0, s21, 3072
    s_add_u32 s3, s22, 73728
    buffer_load_dwordx4 v148, s[40:43], s3 offen lds
    s_add_u32 s3, s23, 262144
    buffer_load_dwordx4 v[88:91], v152, s[8:11], s3 offen sc1
    buffer_load_dwordx4 v[92:95], v153, s[8:11], s3 offen sc1
    s_waitcnt vmcnt(8)
    ds_read_b64_tr_b16 v[104:105], v149 offset:4096
    ds_read_b64_tr_b16 v[106:107], v149 offset:5120
    ds_read_b64_tr_b16 v[108:109], v150 offset:4096
    ds_read_b64_tr_b16 v[110:111], v150 offset:5120
    s_waitcnt lgkmcnt(0)
    v_mfma_f32_32x32x16_bf16 v[16:31], v[104:107], v[96:99], v[16:31]
    v_mfma_f32_32x32x16_bf16 v[48:63], v[104:107], v[100:103], v[48:63]
    v_mfma_f32_32x32x16_bf16 v[32:47], v[108:111], v[96:99], v[32:47]
    v_mfma_f32_32x32x16_bf16 v[64:79], v[108:111], v[100:103], v[64:79]
    s_add_u32 m0, s21, 4096
    s_add_u32 s3, s22, 81920
    buffer_load_dwordx4 v148, s[40:43], s3 offen lds
    s_add_u32 m0, s21, 5120
    s_add_u32 s3, s22, 90112
    buffer_load_dwordx4 v148, s[40:43], s3 offen lds
    s_add_u32 s3, s23, 327680
    buffer_load_dwordx4 v[96:99], v152, s[8:11], s3 offen sc1
    buffer_load_dwordx4 v[100:103], v153, s[8:11], s3 offen sc1
    s_waitcnt vmcnt(8)
    ds_read_b64_tr_b16 v[104:105], v149 offset:0
    ds_read_b64_tr_b16 v[106:107], v149 offset:1024
    ds_read_b64_tr_b16 v[108:109], v150 offset:0
    ds_read_b64_tr_b16 v[110:111], v150 offset:1024
    s_waitcnt lgkmcnt(0)
    v_mfma_f32_32x32x16_bf16 v[16:31], v[104:107], v[80:83], v[16:31]
    v_mfma_f32_32x32x16_bf16 v[48:63], v[104:107], v[84:87], v[48:63]
    v_mfma_f32_32x32x16_bf16 v[32:47], v[108:111], v[80:83], v[32:47]
    v_mfma_f32_32x32x16_bf16 v[64:79], v[108:111], v[84:87], v[64:79]
    s_add_u32 m0, s21, 0
    s_add_u32 s3, s22, 98304
    buffer_load_dwordx4 v148, s[40:43], s3 offen lds
    s_add_u32 m0, s21, 1024
    s_add_u32 s3, s22, 106496
    buffer_load_dwordx4 v148, s[40:43], s3 offen lds
    s_add_u32 s3, s23, 393216
    buffer_load_dwordx4 v[80:83], v152, s[8:11], s3 offen sc1
    buffer_load_dwordx4 v[84:87], v153, s[8:11], s3 offen sc1
    s_waitcnt vmcnt(8)
    ds_read_b64_tr_b16 v[104:105], v149 offset:2048
    ds_read_b64_tr_b16 v[106:107], v149 offset:3072
    ds_read_b64_tr_b16 v[108:109], v150 offset:2048
    ds_read_b64_tr_b16 v[110:111], v150 offset:3072
    s_waitcnt lgkmcnt(0)
    v_mfma_f32_32x32x16_bf16 v[16:31], v[104:107], v[88:91], v[16:31]
    v_mfma_f32_32x32x16_bf16 v[48:63], v[104:107], v[92:95], v[48:63]
    v_mfma_f32_32x32x16_bf16 v[32:47], v[108:111], v[88:91], v[32:47]
    v_mfma_f32_32x32x16_bf16 v[64:79], v[108:111], v[92:95], v[64:79]
    s_add_u32 m0, s21, 2048
    s_add_u32 s3, s22, 114688
    buffer_load_dwordx4 v148, s[40:43], s3 offen lds
    s_add_u32 m0, s21, 3072
    s_add_u32 s3, s22, 122880
    buffer_load_dwordx4 v148, s[40:43], s3 offen lds
    s_add_u32 s3, s23, 458752
    buffer_load_dwordx4 v[88:91], v152, s[8:11], s3 offen sc1
    buffer_load_dwordx4 v[92:95], v153, s[8:11], s3 offen sc1
    s_waitcnt vmcnt(8)
    ds_read_b64_tr_b16 v[104:105], v149 offset:4096
    ds_read_b64_tr_b16 v[106:107], v149 offset:5120
    ds_read_b64_tr_b16 v[108:109], v150 offset:4096
    ds_read_b64_tr_b16 v[110:111], v150 offset:5120
    s_waitcnt lgkmcnt(0)
    v_mfma_f32_32x32x16_bf16 v[16:31], v[104:107], v[96:99], v[16:31]
    v_mfma_f32_32x32x16_bf16 v[48:63], v[104:107], v[100:103], v[48:63]
    v_mfma_f32_32x32x16_bf16 v[32:47], v[108:111], v[96:99], v[32:47]
    v_mfma_f32_32x32x16_bf16 v[64:79], v[108:111], v[100:103], v[64:79]
    s_waitcnt vmcnt(4)
    ds_read_b64_tr_b16 v[104:105], v149 offset:0
    ds_read_b64_tr_b16 v[106:107], v149 offset:1024
    ds_read_b64_tr_b16 v[108:109], v150 offset:0
    ds_read_b64_tr_b16 v[110:111], v150 offset:1024
    s_waitcnt lgkmcnt(0)
    v_mfma_f32_32x32x16_bf16 v[16:31], v[104:107], v[80:83], v[16:31]
    v_mfma_f32_32x32x16_bf16 v[48:63], v[104:107], v[84:87], v[48:63]
    v_mfma_f32_32x32x16_bf16 v[32:47], v[108:111], v[80:83], v[32:47]
    v_mfma_f32_32x32x16_bf16 v[64:79], v[108:111], v[84:87], v[64:79]
    s_waitcnt vmcnt(0)
    ds_read_b64_tr_b16 v[104:105], v149 offset:2048
    ds_read_b64_tr_b16 v[106:107], v149 offset:3072
    ds_read_b64_tr_b16 v[108:109], v150 offset:2048
    ds_read_b64_tr_b16 v[110:111], v150 offset:3072
    s_waitcnt lgkmcnt(0)
    v_mfma_f32_32x32x16_bf16 v[16:31], v[104:107], v[88:91], v[16:31]
    v_mfma_f32_32x32x16_bf16 v[48:63], v[104:107], v[92:95], v[48:63]
    v_mfma_f32_32x32x16_bf16 v[32:47], v[108:111], v[88:91], v[32:47]
    v_mfma_f32_32x32x16_bf16 v[64:79], v[108:111], v[92:95], v[64:79]
HM_ap:
Lp25:
    ds_read_b32 v3, v2 offset:80
    s_waitcnt lgkmcnt(0)
    v_readfirstlane_b32 s3, v3
    s_cmp_ge_u32 s3, 8
    s_cbranch_scc1 Lq26
    s_sleep 12
    s_branch Lp25
Lq26:
    s_lshl_b32 s19, s28, 14
    ds_write_b128 v158, v[32:35] offset:4096
    ds_write_b128 v158, v[36:39] offset:5120
    ds_write_b128 v158, v[40:43] offset:6144
    ds_write_b128 v158, v[44:47] offset:7168
    ds_write_b128 v158, v[48:51] offset:8192
    ds_write_b128 v158, v[52:55] offset:9216
    ds_write_b128 v158, v[56:59] offset:10240
    ds_write_b128 v158, v[60:63] offset:11264
    ds_write_b128 v158, v[64:67] offset:12288
    ds_write_b128 v158, v[68:71] offset:13312
    ds_write_b128 v158, v[72:75] offset:14336
    ds_write_b128 v158, v[76:79] offset:15360
    s_waitcnt lgkmcnt(0)
    v_mov_b32 v3, 1
    s_mov_b64 exec, 1
    ds_add_u32 v2, v3 offset:20
    s_mov_b64 exec, -1
Lp27:
    ds_read_b32 v3, v2 offset:20
    s_waitcnt lgkmcnt(0)
    v_readfirstlane_b32 s3, v3
    s_cmp_ge_u32 s3, 4
    s_cbranch_scc1 Lq28
    s_sleep 2
    s_branch Lp27
Lq28:
    ds_read_b128 v[32:35], v159 offset:4096
    ds_read_b128 v[36:39], v159 offset:5120
    ds_read_b128 v[40:43], v159 offset:6144
    ds_read_b128 v[44:47], v159 offset:7168
    ds_read_b128 v[48:51], v160 offset:8192
    ds_read_b128 v[52:55], v160 offset:9216
    ds_read_b128 v[56:59], v160 offset:10240
    ds_read_b128 v[60:63], v160 offset:11264
    ds_read_b128 v[64:67], v161 offset:12288
    ds_read_b128 v[68:71], v161 offset:13312
    ds_read_b128 v[72:75], v161 offset:14336
    ds_read_b128 v[76:79], v161 offset:15360
    s_waitcnt lgkmcnt(0)
    v_mov_b32 v3, 1
    s_mov_b64 exec, 1
    ds_add_u32 v2, v3 offset:20
    s_mov_b64 exec, -1
    s_mov_b32 s40, s76
    s_mov_b32 s41, s77
    s_mov_b32 s42, 524288
    s_mov_b32 s43, 0x00020000
    s_mov_b32 s48, s56
    s_mov_b32 s49, s57
    s_mov_b32 s50, 2097152
    s_mov_b32 s51, 0x00020000
Lp29:
    ds_read_b32 v3, v2 offset:20
    s_waitcnt lgkmcnt(0)
    v_readfirstlane_b32 s3, v3
    s_cmp_ge_u32 s3, 8
    s_cbranch_scc1 Lq30
    s_sleep 2
    s_branch Lp29
Lq30:
    s_add_u32 m0, s19, 0
    s_add_u32 s3, s22, 0
    buffer_load_dwordx4 v148, s[40:43], s3 offen lds
    s_add_u32 m0, s19, 1024
    s_add_u32 s3, s22, 8192
    buffer_load_dwordx4 v148, s[40:43], s3 offen lds
    s_add_u32 m0, s19, 2048
    s_add_u32 s3, s22, 16384
    buffer_load_dwordx4 v148, s[40:43], s3 offen lds
    s_add_u32 m0, s19, 3072
    s_add_u32 s3, s22, 24576
    buffer_load_dwordx4 v148, s[40:43], s3 offen lds
    s_add_u32 m0, s19, 4096
    s_add_u32 s3, s22, 32768
    buffer_load_dwordx4 v148, s[40:43], s3 offen lds
    s_add_u32 m0, s19, 5120
    s_add_u32 s3, s22, 40960
    buffer_load_dwordx4 v148, s[40:43], s3 offen lds
    s_add_u32 m0, s19, 6144
    s_add_u32 s3, s22, 49152
    buffer_load_dwordx4 v148, s[40:43], s3 offen lds
    s_add_u32 m0, s19, 7168
    s_add_u32 s3, s22, 57344
    buffer_load_dwordx4 v148, s[40:43], s3 offen lds
    s_add_u32 m0, s19, 8192
    s_add_u32 s3, s22, 65536
    buffer_load_dwordx4 v148, s[40:43], s3 offen lds
    s_add_u32 m0, s19, 9216
    s_add_u32 s3, s22, 73728
    buffer_load_dwordx4 v148, s[40:43], s3 offen lds
    s_add_u32 m0, s19, 10240
    s_add_u32 s3, s22, 81920
    buffer_load_dwordx4 v148, s[40:43], s3 offen lds
    s_add_u32 m0, s19, 11264
    s_add_u32 s3, s22, 90112
    buffer_load_dwordx4 v148, s[40:43], s3 offen lds
    s_add_u32 m0, s19, 12288
    s_add_u32 s3, s22, 98304
    buffer_load_dwordx4 v148, s[40:43], s3 offen lds
    s_add_u32 m0, s19, 13312
    s_add_u32 s3, s22, 106496
    buffer_load_dwordx4 v148, s[40:43], s3 offen lds
    s_add_u32 m0, s19, 14336
    s_add_u32 s3, s22, 114688
    buffer_load_dwordx4 v148, s[40:43], s3 offen lds
    s_add_u32 m0, s19, 15360
    s_add_u32 s3, s22, 122880
    buffer_load_dwordx4 v148, s[40:43], s3 offen lds
    s_lshl_b32 s23, s37, 7
    s_and_b32 s3, s28, 1
    s_lshl_b32 s3, s3, 6
    s_add_u32 s23, s23, s3
    s_waitcnt vmcnt(0)
    v_mov_b32 v3, 1
    s_mov_b64 exec, 1
    ds_add_u32 v2, v3 offset:84
    s_mov_b64 exec, -1
Lp31:
    ds_read_b32 v3, v2 offset:84
    s_waitcnt lgkmcnt(0)
    v_readfirstlane_b32 s3, v3
    s_cmp_ge_u32 s3, 4
    s_cbranch_scc1 Lq32
    s_sleep 2
    s_branch Lp31
Lq32:
HM_wb:
    s_setprio 0
Lp33:
    ds_read_b32 v3, v2 offset:12
    s_waitcnt lgkmcnt(0)
    v_readfirstlane_b32 s3, v3
    s_cmp_ge_u32 s3, 4
    s_cbranch_scc1 Lq34
    s_sleep 8
    s_branch Lp33
Lq34:
    s_setprio 3
HM_ob4:
Lp35:
    ds_read_b32 v3, v2 offset:12
    s_waitcnt lgkmcnt(0)
    v_readfirstlane_b32 s3, v3
    s_cmp_ge_u32 s3, 8
    s_cbranch_scc1 Lq36
    s_sleep 2
    s_branch Lp35
Lq36:
    v_pk_add_f32 v[16:17], v[16:17], v[32:33]
    v_pk_add_f32 v[48:49], v[48:49], v[64:65]
    v_pk_add_f32 v[18:19], v[18:19], v[34:35]
    v_pk_add_f32 v[50:51], v[50:51], v[66:67]
    v_pk_add_f32 v[20:21], v[20:21], v[36:37]
    v_pk_add_f32 v[52:53], v[52:53], v[68:69]
    v_pk_add_f32 v[22:23], v[22:23], v[38:39]
    v_pk_add_f32 v[54:55], v[54:55], v[70:71]
    v_pk_add_f32 v[24:25], v[24:25], v[40:41]
    v_pk_add_f32 v[56:57], v[56:57], v[72:73]
    v_pk_add_f32 v[26:27], v[26:27], v[42:43]
    v_pk_add_f32 v[58:59], v[58:59], v[74:75]
    v_pk_add_f32 v[28:29], v[28:29], v[44:45]
    v_pk_add_f32 v[60:61], v[60:61], v[76:77]
    v_pk_add_f32 v[30:31], v[30:31], v[46:47]
    v_pk_add_f32 v[62:63], v[62:63], v[78:79]
    v_pk_add_f32 v[16:17], v[16:17], v[48:49]
    v_pk_add_f32 v[18:19], v[18:19], v[50:51]
    v_pk_add_f32 v[20:21], v[20:21], v[52:53]
    v_pk_add_f32 v[22:23], v[22:23], v[54:55]
    v_pk_add_f32 v[24:25], v[24:25], v[56:57]
    v_pk_add_f32 v[26:27], v[26:27], v[58:59]
    v_pk_add_f32 v[28:29], v[28:29], v[60:61]
    v_pk_add_f32 v[30:31], v[30:31], v[62:63]
    v_pk_mul_f32 v[16:17], v[16:17], v[14:15] op_sel_hi:[1,0]
    v_pk_mul_f32 v[18:19], v[18:19], v[14:15] op_sel_hi:[1,0]
    v_pk_mul_f32 v[20:21], v[20:21], v[14:15] op_sel_hi:[1,0]
    v_pk_mul_f32 v[22:23], v[22:23], v[14:15] op_sel_hi:[1,0]
    v_pk_mul_f32 v[24:25], v[24:25], v[14:15] op_sel_hi:[1,0]
    v_pk_mul_f32 v[26:27], v[26:27], v[14:15] op_sel_hi:[1,0]
    v_pk_mul_f32 v[28:29], v[28:29], v[14:15] op_sel_hi:[1,0]
    v_pk_mul_f32 v[30:31], v[30:31], v[14:15] op_sel_hi:[1,0]
    v_mov_b64 v[32:33], 0
    v_mov_b64 v[34:35], 0
    v_mov_b64 v[36:37], 0
    v_mov_b64 v[38:39], 0
    v_mov_b64 v[40:41], 0
    v_mov_b64 v[42:43], 0
    v_mov_b64 v[44:45], 0
    v_mov_b64 v[46:47], 0
    v_sub_f32 v12, 1.0, v14
    v_cvt_pk_bf16_f32 v12, v12, v12
    v_lshlrev_b32 v12, 16, v12
    s_mov_b32 s30, 0xff
H3_poll:
    ds_read_b32 v3, v2 offset:88
    s_waitcnt lgkmcnt(0)
    v_readfirstlane_b32 s31, v3
    s_nop 0
    s_and_b32 s31, s31, s30
    s_cbranch_scc1 H3_go
    s_sleep 1
    s_branch H3_poll
H3_go:
    s_ff1_i32_b32 s3, s31
    s_bitset0_b32 s31, s3
    s_bitset0_b32 s30, s3
    s_lshl_b32 s3, s3, 13
    v_add_u32 v8, s3, v156
    v_add_u32 v9, s3, v157
    ds_read_b128 v[48:51], v9 offset:0
    ds_read_b64_tr_b16 v[52:53], v8 offset:0
    ds_read_b64_tr_b16 v[54:55], v8 offset:1024
    ds_read_b128 v[56:59], v9 offset:2048
    ds_read_b64_tr_b16 v[60:61], v8 offset:2048
    ds_read_b64_tr_b16 v[62:63], v8 offset:3072
    ds_read_b128 v[64:67], v9 offset:4096
    ds_read_b64_tr_b16 v[68:69], v8 offset:4096
    ds_read_b64_tr_b16 v[70:71], v8 offset:5120
    ds_read_b128 v[72:75], v9 offset:6144
    ds_read_b64_tr_b16 v[76:77], v8 offset:6144
    ds_read_b64_tr_b16 v[78:79], v8 offset:7168
H3_a:
    s_waitcnt lgkmcnt(0)
    s_cmp_eq_u32 s31, 0
    s_cbranch_scc1 H3_a1
    s_ff1_i32_b32 s3, s31
    s_bitset0_b32 s31, s3
    s_bitset0_b32 s30, s3
    s_lshl_b32 s3, s3, 13
    v_add_u32 v8, s3, v156
    v_add_u32 v9, s3, v157
    ds_read_b128 v[80:83], v9 offset:0
    ds_read_b64_tr_b16 v[84:85], v8 offset:0
    ds_read_b64_tr_b16 v[86:87], v8 offset:1024
    ds_read_b128 v[88:91], v9 offset:2048
    ds_read_b64_tr_b16 v[92:93], v8 offset:2048
    ds_read_b64_tr_b16 v[94:95], v8 offset:3072
    ds_read_b128 v[96:99], v9 offset:4096
    ds_read_b64_tr_b16 v[100:101], v8 offset:4096
    ds_read_b64_tr_b16 v[102:103], v8 offset:5120
    ds_read_b128 v[104:107], v9 offset:6144
    ds_read_b64_tr_b16 v[108:109], v8 offset:6144
    ds_read_b64_tr_b16 v[110:111], v8 offset:7168
    v_mfma_f32_32x32x16_bf16 v[32:47], v[52:55], v[48:51], v[32:47]
    v_mfma_f32_32x32x16_bf16 v[32:47], v[60:63], v[56:59], v[32:47]
    v_mfma_f32_32x32x16_bf16 v[32:47], v[68:71], v[64:67], v[32:47]
    v_mfma_f32_32x32x16_bf16 v[32:47], v[76:79], v[72:75], v[32:47]
    s_waitcnt lgkmcnt(0)
    s_cmp_eq_u32 s31, 0
    s_cbranch_scc1 H3_b1
    s_ff1_i32_b32 s3, s31
    s_bitset0_b32 s31, s3
    s_bitset0_b32 s30, s3
    s_lshl_b32 s3, s3, 13
    v_add_u32 v8, s3, v156
    v_add_u32 v9, s3, v157
    ds_read_b128 v[48:51], v9 offset:0
    ds_read_b64_tr_b16 v[52:53], v8 offset:0
    ds_read_b64_tr_b16 v[54:55], v8 offset:1024
    ds_read_b128 v[56:59], v9 offset:2048
    ds_read_b64_tr_b16 v[60:61], v8 offset:2048
    ds_read_b64_tr_b16 v[62:63], v8 offset:3072
    ds_read_b128 v[64:67], v9 offset:4096
    ds_read_b64_tr_b16 v[68:69], v8 offset:4096
    ds_read_b64_tr_b16 v[70:71], v8 offset:5120
    ds_read_b128 v[72:75], v9 offset:6144
    ds_read_b64_tr_b16 v[76:77], v8 offset:6144
    ds_read_b64_tr_b16 v[78:79], v8 offset:7168
    v_mfma_f32_32x32x16_bf16 v[32:47], v[84:87], v[80:83], v[32:47]
    v_mfma_f32_32x32x16_bf16 v[32:47], v[92:95], v[88:91], v[32:47]
    v_mfma_f32_32x32x16_bf16 v[32:47], v[100:103], v[96:99], v[32:47]
    v_mfma_f32_32x32x16_bf16 v[32:47], v[108:111], v[104:107], v[32:47]
    s_branch H3_a
H3_a1:
    v_mfma_f32_32x32x16_bf16 v[32:47], v[52:55], v[48:51], v[32:47]
    v_mfma_f32_32x32x16_bf16 v[32:47], v[60:63], v[56:59], v[32:47]
    v_mfma_f32_32x32x16_bf16 v[32:47], v[68:71], v[64:67], v[32:47]
    v_mfma_f32_32x32x16_bf16 v[32:47], v[76:79], v[72:75], v[32:47]
    s_branch H3_c
H3_b1:
    v_mfma_f32_32x32x16_bf16 v[32:47], v[84:87], v[80:83], v[32:47]
    v_mfma_f32_32x32x16_bf16 v[32:47], v[92:95], v[88:91], v[32:47]
    v_mfma_f32_32x32x16_bf16 v[32:47], v[100:103], v[96:99], v[32:47]
    v_mfma_f32_32x32x16_bf16 v[32:47], v[108:111], v[104:107], v[32:47]
H3_c:
    s_cmp_lg_u32 s30, 0
    s_cbranch_scc1 H3_poll
HM_mm:
    s_nop 1
    s_nop 7
    v_pk_fma_f32 v[32:33], v[32:33], v[12:13], v[16:17] op_sel_hi:[1,0,1]
    v_pk_fma_f32 v[34:35], v[34:35], v[12:13], v[18:19] op_sel_hi:[1,0,1]
    v_pk_fma_f32 v[36:37], v[36:37], v[12:13], v[20:21] op_sel_hi:[1,0,1]
    v_pk_fma_f32 v[38:39], v[38:39], v[12:13], v[22:23] op_sel_hi:[1,0,1]
    v_pk_fma_f32 v[40:41], v[40:41], v[12:13], v[24:25] op_sel_hi:[1,0,1]
    v_pk_fma_f32 v[42:43], v[42:43], v[12:13], v[26:27] op_sel_hi:[1,0,1]
    v_pk_fma_f32 v[44:45], v[44:45], v[12:13], v[28:29] op_sel_hi:[1,0,1]
    v_pk_fma_f32 v[46:47], v[46:47], v[12:13], v[30:31] op_sel_hi:[1,0,1]
    v_cvt_pk_bf16_f32 v112, v32, v33
    v_cvt_pk_bf16_f32 v113, v34, v35
    v_cvt_pk_bf16_f32 v114, v36, v37
    v_cvt_pk_bf16_f32 v115, v38, v39
    v_cvt_pk_bf16_f32 v116, v40, v41
    v_cvt_pk_bf16_f32 v117, v42, v43
    v_cvt_pk_bf16_f32 v118, v44, v45
    v_cvt_pk_bf16_f32 v119, v46, v47
    s_nop 1
    v_permlane32_swap_b32 v112, v114
    v_permlane32_swap_b32 v113, v115
    v_permlane32_swap_b32 v116, v118
    v_permlane32_swap_b32 v117, v119
    buffer_store_dwordx4 v[112:115], v155, s[48:51], s23 offen
    buffer_store_dwordx4 v[116:119], v155, s[48:51], s23 offen offset:32
HM_fin:
HM_end:
    s_branch K_end
P1_compute:
    s_sub_u32 s12, s28, 4
    s_mov_b32 s46, 0
    s_and_b32 s30, s12, 1
    s_lshr_b32 s48, s12, 1
    s_and_b32 s48, s48, 1
    s_lshr_b32 s31, s12, 2
    s_lshl_b32 s32, s30, 1
    s_add_u32 s32, s32, s31
    v_and_b32 v1, 31, v0
    v_lshrrev_b32 v2, 5, v0
    v_lshrrev_b32 v3, 1, v1
    v_and_b32 v3, 7, v3
    v_xor_b32 v3, v3, v2
    v_lshlrev_b32 v3, 4, v3
    s_lshl_b32 s3, s30, 6
    v_add_u32 v4, s3, v1
    v_lshlrev_b32 v4, 7, v4
    v_add_u32 v4, v4, v3
    v_xor_b32 v5, 32, v4
    v_xor_b32 v6, 64, v4
    v_xor_b32 v7, 96, v4
    v_and_b32 v3, 15, v0
    v_lshrrev_b32 v8, 2, v3
    v_lshlrev_b32 v9, 3, v2
    v_add_u32 v8, v8, v9
    v_lshlrev_b32 v8, 7, v8
    v_and_b32 v9, 8, v0
    v_lshlrev_b32 v9, 3, v9
    s_lshl_b32 s3, s48, 6
    v_xor_b32 v9, s3, v9
    v_add_u32 v8, v8, v9
    v_and_b32 v9, 16, v0
    v_cmp_ne_u32 s[6:7], 0, v9
    v_lshlrev_b32 v9, 1, v9
    v_add_u32 v8, v8, v9
    v_and_b32 v9, 3, v0
    v_lshlrev_b32 v9, 3, v9
    v_add_u32 v8, v8, v9
    v_add_u32 v8, 16384, v8
    v_mov_b64 v[162:163], 0
    v_mov_b32 v164, 0
    s_waitcnt lgkmcnt(0)
    s_mov_b32 s8, s60
    s_mov_b32 s9, s61
    s_mov_b32 s10, 18874368
    s_mov_b32 s11, 0x00020000
    s_cmp_lt_u32 s12, 4
    s_cbranch_scc1 P1_gemm
    s_getpc_b64 s[42:43]
Lc37:
    s_add_u32 s42, s42, SU_a-Lc37
    s_addc_u32 s43, s43, 0
    s_swappc_b64 s[44:45], s[42:43]
    s_getpc_b64 s[42:43]
Lc38:
    s_add_u32 s42, s42, SU_b-Lc38
    s_addc_u32 s43, s43, 0
    s_swappc_b64 s[44:45], s[42:43]
    s_getpc_b64 s[42:43]
Lc39:
    s_add_u32 s42, s42, SU_c-Lc39
    s_addc_u32 s43, s43, 0
    s_swappc_b64 s[44:45], s[42:43]
    s_barrier
    s_barrier
    s_barrier
    s_barrier
    s_barrier
    s_barrier
    s_barrier
    s_barrier
    s_barrier
    s_waitcnt vmcnt(0)
    ds_read_b64_tr_b16 v[96:97], v10 offset:0
    ds_read_b64_tr_b16 v[98:99], v10 offset:256
    ds_read_b64_tr_b16 v[100:101], v10 offset:512
    ds_read_b64_tr_b16 v[102:103], v10 offset:768
    ds_read_b64 v[12:13], v3 offset:24
    s_waitcnt lgkmcnt(0)
    v_readfirstlane_b32 s34, v12
    v_readfirstlane_b32 s35, v13
Lp40:
    ds_read_b32 v12, v3 offset:64
    s_waitcnt lgkmcnt(0)
    v_readfirstlane_b32 s3, v12
    s_cmp_ge_u32 s3, 4
    s_cbranch_scc1 Lq41
    s_sleep 1
    s_branch Lp40
Lq41:
    ds_read_b128 v[64:67], v11 offset:0
    ds_read_b128 v[68:71], v11 offset:1024
    ds_read_b128 v[72:75], v11 offset:2048
    ds_read_b128 v[76:79], v11 offset:3072
    s_waitcnt lgkmcnt(0)
    s_branch P1_feat
SU_a:
    s_lshl_b32 s51, s37, 2
    s_lshl_b32 s3, s48, 1
    s_add_u32 s51, s51, s3
    v_and_b32 v10, 15, v0
    v_lshrrev_b32 v10, 2, v10
    v_and_b32 v9, 3, v0
    v_lshlrev_b32 v9, 3, v9
    v_lshlrev_b32 v11, 2, v2
    v_add_u32 v10, v10, v11
    v_lshlrev_b32 v10, 5, v10
    s_lshl_b32 s3, s48, 10
    s_add_u32 s3, s3, 131072
    v_add3_u32 v10, v10, v9, s3
    v_lshlrev_b32 v9, 4, v0
    v_mov_b32 v3, 135168
    s_and_b32 s3, s12, 3
    s_lshl_b32 s3, s3, 12
    s_add_u32 s3, s3, 139264
    v_add_u32 v11, s3, v9
    s_lshl_b32 s62, s37, 12
    s_lshl_b32 s3, s33, 8
    s_add_u32 s62, s62, s3
    s_lshl_b32 s3, s38, 7
    s_add_u32 s62, s62, s3
    s_add_u32 s63, s62, 17891328
    s_add_u32 s62, s62, 17924096
    s_lshl_b32 s39, s37, 11
    s_lshl_b32 s3, s33, 7
    s_add_u32 s39, s39, s3
    s_add_u32 s39, s39, 17956864
    s_lshl_b32 s3, s33, 2
    s_add_u32 s3, s3, s32
    s_lshl_b32 s29, s51, 6
    s_add_u32 s29, s29, s3
    s_setpc_b64 s[44:45]
SU_b:
    v_lshlrev_b32 v12, 2, v2
    v_sub_u32 v12, v1, v12
    v_mov_b32 v13, 0x3f80
    v_mov_b32 v14, 0x3f800000
    v_cmp_eq_u32 s[4:5], 0, v12
    v_cmp_eq_u32 s[30:31], 1, v12
    s_nop 1
    v_cndmask_b32 v15, 0, v13, s[4:5]
    v_cndmask_b32 v152, v15, v14, s[30:31]
    v_cmp_eq_u32 s[4:5], 2, v12
    v_cmp_eq_u32 s[30:31], 3, v12
    s_nop 1
    v_cndmask_b32 v15, 0, v13, s[4:5]
    v_cndmask_b32 v153, v15, v14, s[30:31]
    v_cmp_eq_u32 s[4:5], 8, v12
    v_cmp_eq_u32 s[30:31], 9, v12
    s_nop 1
    v_cndmask_b32 v15, 0, v13, s[4:5]
    v_cndmask_b32 v154, v15, v14, s[30:31]
    v_cmp_eq_u32 s[4:5], 10, v12
    v_cmp_eq_u32 s[30:31], 11, v12
    s_nop 1
    v_cndmask_b32 v15, 0, v13, s[4:5]
    v_cndmask_b32 v155, v15, v14, s[30:31]
    v_cmp_eq_u32 s[4:5], 16, v12
    v_cmp_eq_u32 s[30:31], 17, v12
    s_nop 1
    v_cndmask_b32 v15, 0, v13, s[4:5]
    v_cndmask_b32 v156, v15, v14, s[30:31]
    v_cmp_eq_u32 s[4:5], 18, v12
    v_cmp_eq_u32 s[30:31], 19, v12
    s_nop 1
    v_cndmask_b32 v15, 0, v13, s[4:5]
    v_cndmask_b32 v157, v15, v14, s[30:31]
    v_cmp_eq_u32 s[4:5], 24, v12
    v_cmp_eq_u32 s[30:31], 25, v12
    s_nop 1
    v_cndmask_b32 v15, 0, v13, s[4:5]
    v_cndmask_b32 v158, v15, v14, s[30:31]
    v_cmp_eq_u32 s[4:5], 26, v12
    v_cmp_eq_u32 s[30:31], 27, v12
    s_nop 1
    v_cndmask_b32 v15, 0, v13, s[4:5]
    v_cndmask_b32 v159, v15, v14, s[30:31]
    s_setpc_b64 s[44:45]
SU_c:
    s_lshl_b32 s3, s48, 2
    s_add_u32 s3, s3, s32
    s_lshl_b32 s3, s3, 13
    s_add_u32 s3, s3, 65536
    v_add_u32 v160, s3, v9
    s_lshl_b32 s3, s32, 11
    s_lshl_b32 s4, s48, 15
    s_add_u32 s3, s3, s4
    s_add_u32 s3, s3, 65536
    v_add_u32 v161, s3, v9
    s_lshr_b32 s3, s32, 1
    s_lshl_b32 s4, s3, 4
    v_xor_b32 v12, s4, v1
    s_lshl_b32 s4, s33, 5
    s_add_u32 s4, s4, s51
    s_add_u32 s4, s4, s3
    s_lshl_b32 s4, s4, 3
    s_and_b32 s5, s32, 1
    s_lshl_b32 s5, s5, 2
    s_add_u32 s4, s4, s5
    s_lshl_b32 s5, s4, 8
    s_add_u32 s5, s5, 10485760
    s_and_b32 s4, s4, 255
    s_lshl_b32 s4, s4, 4
    s_lshl_b32 s3, s33, 16
    s_add_u32 s4, s4, s3
    s_add_u32 s4, s4, 11534336
    v_lshlrev_b32 v13, 7, v2
    v_lshlrev_b32 v14, 3, v12
    v_add3_u32 v13, v13, v14, s5
    v_lshlrev_b32 v14, 3, v2
    v_add_u32 v14, s4, v14
    v_cmp_gt_u32 s[4:5], 16, v12
    v_cmp_eq_u32 s[30:31], 16, v12
    v_mov_b32 v15, 0x7ffff000
    v_mov_b32 v163, 256
    v_cndmask_b32 v14, v15, v14, s[30:31]
    v_cndmask_b32 v162, v14, v13, s[4:5]
    v_cndmask_b32 v163, 16, v163, s[4:5]
    v_and_b32 v164, 16, v0
    v_lshlrev_b32 v164, 13, v164
    v_and_b32 v15, 0x2f, v0
    v_lshlrev_b32 v15, 4, v15
    v_add_u32 v164, v164, v15
    s_setpc_b64 s[44:45]
P1_gemm:
    v_mov_b64 v[12:13], 0
    v_mov_b64 v[14:15], 0
    s_nop 1
    v_mfma_f32_32x32x16_bf16 v[16:31], v[12:15], v[12:15], 0
    v_mfma_f32_32x32x16_bf16 v[32:47], v[12:15], v[12:15], 0
    v_mfma_f32_32x32x16_bf16 v[48:63], v[12:15], v[12:15], 0
    v_mfma_f32_32x32x16_bf16 v[64:79], v[12:15], v[12:15], 0
    v_mfma_f32_32x32x16_bf16 v[80:95], v[12:15], v[12:15], 0
    v_mfma_f32_32x32x16_bf16 v[96:111], v[12:15], v[12:15], 0
    s_getpc_b64 s[42:43]
Lc42:
    s_sub_u32 s42, s42, Lc42-SU_a
    s_subb_u32 s43, s43, 0
    s_swappc_b64 s[44:45], s[42:43]
    s_getpc_b64 s[42:43]
Lc43:
    s_sub_u32 s42, s42, Lc43-SU_b
    s_subb_u32 s43, s43, 0
    s_swappc_b64 s[44:45], s[42:43]
    s_getpc_b64 s[42:43]
Lc44:
    s_sub_u32 s42, s42, Lc44-SU_c
    s_subb_u32 s43, s43, 0
    s_swappc_b64 s[44:45], s[42:43]
    s_mov_b32 s49, 0
    s_mov_b32 s50, 0
    s_barrier
    ds_read_b128 v[112:115], v4
    ds_read_b64_tr_b16 v[128:129], v8 offset:16384
    ds_read_b64_tr_b16 v[130:131], v8 offset:16896
    ds_read_b128 v[116:119], v4 offset:4096
    ds_read_b64_tr_b16 v[124:125], v8 offset:8192
    ds_read_b64_tr_b16 v[126:127], v8 offset:8704
    ds_read_b64_tr_b16 v[120:121], v8 offset:0
    ds_read_b64_tr_b16 v[122:123], v8 offset:512
    s_cmp_eq_u32 s38, 0
    s_cbranch_scc1 P1_loopK
P1_loopQ:
    s_waitcnt lgkmcnt(5)
    v_mfma_f32_32x32x16_bf16 v[48:63], v[128:131], v[112:115], v[48:63]
    ds_read_b128 v[132:135], v5
    ds_read_b64_tr_b16 v[148:149], v8 offset:18432
    s_waitcnt lgkmcnt(6)
    v_mfma_f32_32x32x16_bf16 v[96:111], v[128:131], v[116:119], v[96:111]
    ds_read_b64_tr_b16 v[150:151], v8 offset:18944
    ds_read_b128 v[136:139], v5 offset:4096
    s_waitcnt lgkmcnt(6)
    v_mfma_f32_32x32x16_bf16 v[32:47], v[124:127], v[112:115], v[32:47]
    ds_read_b64_tr_b16 v[144:145], v8 offset:10240
    ds_read_b64_tr_b16 v[146:147], v8 offset:10752
    v_mfma_f32_32x32x16_bf16 v[80:95], v[124:127], v[116:119], v[80:95]
    ds_read_b64_tr_b16 v[140:141], v8 offset:2048
    ds_read_b64_tr_b16 v[142:143], v8 offset:2560
    s_waitcnt lgkmcnt(8)
    v_mfma_f32_32x32x16_bf16 v[16:31], v[120:123], v[112:115], v[16:31]
    v_mfma_f32_32x32x16_bf16 v[64:79], v[120:123], v[116:119], v[64:79]
    s_waitcnt lgkmcnt(5)
    v_mfma_f32_32x32x16_bf16 v[48:63], v[148:151], v[132:135], v[48:63]
    ds_read_b128 v[112:115], v6
    ds_read_b64_tr_b16 v[128:129], v8 offset:20480
    s_waitcnt lgkmcnt(6)
    v_mfma_f32_32x32x16_bf16 v[96:111], v[148:151], v[136:139], v[96:111]
    ds_read_b64_tr_b16 v[130:131], v8 offset:20992
    ds_read_b128 v[116:119], v6 offset:4096
    s_waitcnt lgkmcnt(6)
    v_mfma_f32_32x32x16_bf16 v[32:47], v[144:147], v[132:135], v[32:47]
    ds_read_b64_tr_b16 v[124:125], v8 offset:12288
    ds_read_b64_tr_b16 v[126:127], v8 offset:12800
    v_mfma_f32_32x32x16_bf16 v[80:95], v[144:147], v[136:139], v[80:95]
    ds_read_b64_tr_b16 v[120:121], v8 offset:4096
    ds_read_b64_tr_b16 v[122:123], v8 offset:4608
    s_waitcnt lgkmcnt(8)
    v_mfma_f32_32x32x16_bf16 v[16:31], v[140:143], v[132:135], v[16:31]
    v_mfma_f32_32x32x16_bf16 v[64:79], v[140:143], v[136:139], v[64:79]
    s_waitcnt lgkmcnt(5)
    v_mfma_f32_32x32x16_bf16 v[48:63], v[128:131], v[112:115], v[48:63]
    ds_read_b128 v[132:135], v7
    ds_read_b64_tr_b16 v[148:149], v8 offset:22528
    s_waitcnt lgkmcnt(6)
    v_mfma_f32_32x32x16_bf16 v[96:111], v[128:131], v[116:119], v[96:111]
    ds_read_b64_tr_b16 v[150:151], v8 offset:23040
    ds_read_b128 v[136:139], v7 offset:4096
    s_waitcnt lgkmcnt(6)
    v_mfma_f32_32x32x16_bf16 v[32:47], v[124:127], v[112:115], v[32:47]
    ds_read_b64_tr_b16 v[144:145], v8 offset:14336
    ds_read_b64_tr_b16 v[146:147], v8 offset:14848
    v_mfma_f32_32x32x16_bf16 v[80:95], v[124:127], v[116:119], v[80:95]
    ds_read_b64_tr_b16 v[140:141], v8 offset:6144
    ds_read_b64_tr_b16 v[142:143], v8 offset:6656
    s_waitcnt lgkmcnt(8)
    v_mfma_f32_32x32x16_bf16 v[16:31], v[120:123], v[112:115], v[16:31]
    v_mfma_f32_32x32x16_bf16 v[64:79], v[120:123], v[116:119], v[64:79]
    s_waitcnt lgkmcnt(0)
    v_mfma_f32_32x32x16_bf16 v[48:63], v[148:151], v[132:135], v[48:63]
    v_mfma_f32_32x32x16_bf16 v[96:111], v[148:151], v[136:139], v[96:111]
    s_barrier
    s_cmp_eq_u32 s49, 7
    s_cbranch_scc1 P1_lastQ
    s_add_u32 s50, s50, 1
    s_mov_b32 s3, 40960
    s_cmp_eq_u32 s50, 3
    s_cselect_b32 s3, 4294885376, s3
    s_cselect_b32 s50, 0, s50
    v_add_u32 v4, s3, v4
    v_add_u32 v8, s3, v8
    ds_read_b128 v[112:115], v4
    ds_read_b64_tr_b16 v[128:129], v8 offset:16384
    ds_read_b64_tr_b16 v[130:131], v8 offset:16896
    v_mfma_f32_32x32x16_bf16 v[32:47], v[144:147], v[132:135], v[32:47]
    ds_read_b128 v[116:119], v4 offset:4096
    ds_read_b64_tr_b16 v[124:125], v8 offset:8192
    ds_read_b64_tr_b16 v[126:127], v8 offset:8704
    v_mfma_f32_32x32x16_bf16 v[80:95], v[144:147], v[136:139], v[80:95]
    ds_read_b64_tr_b16 v[120:121], v8 offset:0
    ds_read_b64_tr_b16 v[122:123], v8 offset:512
    v_add_u32 v5, s3, v5
    v_add_u32 v6, s3, v6
    v_add_u32 v7, s3, v7
    v_mfma_f32_32x32x16_bf16 v[16:31], v[140:143], v[132:135], v[16:31]
    s_add_u32 s49, s49, 1
    v_mfma_f32_32x32x16_bf16 v[64:79], v[140:143], v[136:139], v[64:79]
    s_branch P1_loopQ
P1_lastQ:
    v_mfma_f32_32x32x16_bf16 v[32:47], v[144:147], v[132:135], v[32:47]
    v_mfma_f32_32x32x16_bf16 v[80:95], v[144:147], v[136:139], v[80:95]
    v_mfma_f32_32x32x16_bf16 v[16:31], v[140:143], v[132:135], v[16:31]
    v_mfma_f32_32x32x16_bf16 v[64:79], v[140:143], v[136:139], v[64:79]
    ds_read_b64 v[12:13], v3 offset:24
    s_lshl_b32 s4, s29, 11
    s_add_u32 s4, s4, 2097152
    s_add_u32 s5, s4, 131072
    s_nop 3
    v_cvt_pk_bf16_f32 v112, v48, v49
    v_cvt_pk_bf16_f32 v113, v50, v51
    v_cvt_pk_bf16_f32 v114, v52, v53
    v_cvt_pk_bf16_f32 v115, v54, v55
    v_cvt_pk_bf16_f32 v116, v56, v57
    v_cvt_pk_bf16_f32 v117, v58, v59
    v_cvt_pk_bf16_f32 v118, v60, v61
    v_cvt_pk_bf16_f32 v119, v62, v63
    v_cvt_pk_bf16_f32 v120, v96, v97
    v_cvt_pk_bf16_f32 v121, v98, v99
    v_cvt_pk_bf16_f32 v122, v100, v101
    v_cvt_pk_bf16_f32 v123, v102, v103
    v_cvt_pk_bf16_f32 v124, v104, v105
    v_cvt_pk_bf16_f32 v125, v106, v107
    v_cvt_pk_bf16_f32 v126, v108, v109
    v_cvt_pk_bf16_f32 v127, v110, v111
    buffer_store_dwordx4 v[112:115], v9, s[8:11], s4 offen offset:0 sc1
    buffer_store_dwordx4 v[116:119], v9, s[8:11], s5 offen offset:0 sc1
    buffer_store_dwordx4 v[120:123], v9, s[8:11], s4 offen offset:2048 sc1
    buffer_store_dwordx4 v[124:127], v9, s[8:11], s5 offen offset:2048 sc1
    s_branch P1_hand
P1_loopK:
    s_waitcnt lgkmcnt(5)
    v_mfma_f32_32x32x16_bf16 v[48:63], v[112:115], v[128:131], v[48:63]
    ds_read_b128 v[132:135], v5
    ds_read_b64_tr_b16 v[148:149], v8 offset:18432
    s_waitcnt lgkmcnt(6)
    v_mfma_f32_32x32x16_bf16 v[96:111], v[116:119], v[128:131], v[96:111]
    ds_read_b64_tr_b16 v[150:151], v8 offset:18944
    ds_read_b128 v[136:139], v5 offset:4096
    s_waitcnt lgkmcnt(6)
    v_mfma_f32_32x32x16_bf16 v[32:47], v[112:115], v[124:127], v[32:47]
    ds_read_b64_tr_b16 v[144:145], v8 offset:10240
    ds_read_b64_tr_b16 v[146:147], v8 offset:10752
    v_mfma_f32_32x32x16_bf16 v[80:95], v[116:119], v[124:127], v[80:95]
    ds_read_b64_tr_b16 v[140:141], v8 offset:2048
    ds_read_b64_tr_b16 v[142:143], v8 offset:2560
    s_waitcnt lgkmcnt(8)
    v_mfma_f32_32x32x16_bf16 v[16:31], v[120:123], v[112:115], v[16:31]
    v_mfma_f32_32x32x16_bf16 v[64:79], v[120:123], v[116:119], v[64:79]
    s_waitcnt lgkmcnt(5)
    v_mfma_f32_32x32x16_bf16 v[48:63], v[132:135], v[148:151], v[48:63]
    ds_read_b128 v[112:115], v6
    ds_read_b64_tr_b16 v[128:129], v8 offset:20480
    s_waitcnt lgkmcnt(6)
    v_mfma_f32_32x32x16_bf16 v[96:111], v[136:139], v[148:151], v[96:111]
    ds_read_b64_tr_b16 v[130:131], v8 offset:20992
    ds_read_b128 v[116:119], v6 offset:4096
    s_waitcnt lgkmcnt(6)
    v_mfma_f32_32x32x16_bf16 v[32:47], v[132:135], v[144:147], v[32:47]
    ds_read_b64_tr_b16 v[124:125], v8 offset:12288
    ds_read_b64_tr_b16 v[126:127], v8 offset:12800
    v_mfma_f32_32x32x16_bf16 v[80:95], v[136:139], v[144:147], v[80:95]
    ds_read_b64_tr_b16 v[120:121], v8 offset:4096
    ds_read_b64_tr_b16 v[122:123], v8 offset:4608
    s_waitcnt lgkmcnt(8)
    v_mfma_f32_32x32x16_bf16 v[16:31], v[140:143], v[132:135], v[16:31]
    v_mfma_f32_32x32x16_bf16 v[64:79], v[140:143], v[136:139], v[64:79]
    s_waitcnt lgkmcnt(5)
    v_mfma_f32_32x32x16_bf16 v[48:63], v[112:115], v[128:131], v[48:63]
    ds_read_b128 v[132:135], v7
    ds_read_b64_tr_b16 v[148:149], v8 offset:22528
    s_waitcnt lgkmcnt(6)
    v_mfma_f32_32x32x16_bf16 v[96:111], v[116:119], v[128:131], v[96:111]
    ds_read_b64_tr_b16 v[150:151], v8 offset:23040
    ds_read_b128 v[136:139], v7 offset:4096
    s_waitcnt lgkmcnt(6)
    v_mfma_f32_32x32x16_bf16 v[32:47], v[112:115], v[124:127], v[32:47]
    ds_read_b64_tr_b16 v[144:145], v8 offset:14336
    ds_read_b64_tr_b16 v[146:147], v8 offset:14848
    v_mfma_f32_32x32x16_bf16 v[80:95], v[116:119], v[124:127], v[80:95]
    ds_read_b64_tr_b16 v[140:141], v8 offset:6144
    ds_read_b64_tr_b16 v[142:143], v8 offset:6656
    s_waitcnt lgkmcnt(8)
    v_mfma_f32_32x32x16_bf16 v[16:31], v[120:123], v[112:115], v[16:31]
    v_mfma_f32_32x32x16_bf16 v[64:79], v[120:123], v[116:119], v[64:79]
    s_waitcnt lgkmcnt(0)
    v_mfma_f32_32x32x16_bf16 v[48:63], v[132:135], v[148:151], v[48:63]
    v_mfma_f32_32x32x16_bf16 v[96:111], v[136:139], v[148:151], v[96:111]
    s_barrier
    s_cmp_eq_u32 s49, 7
    s_cbranch_scc1 P1_lastK
    s_add_u32 s50, s50, 1
    s_mov_b32 s3, 40960
    s_cmp_eq_u32 s50, 3
    s_cselect_b32 s3, 4294885376, s3
    s_cselect_b32 s50, 0, s50
    v_add_u32 v4, s3, v4
    v_add_u32 v8, s3, v8
    ds_read_b128 v[112:115], v4
    ds_read_b64_tr_b16 v[128:129], v8 offset:16384
    ds_read_b64_tr_b16 v[130:131], v8 offset:16896
    v_mfma_f32_32x32x16_bf16 v[32:47], v[132:135], v[144:147], v[32:47]
    ds_read_b128 v[116:119], v4 offset:4096
    ds_read_b64_tr_b16 v[124:125], v8 offset:8192
    ds_read_b64_tr_b16 v[126:127], v8 offset:8704
    v_mfma_f32_32x32x16_bf16 v[80:95], v[136:139], v[144:147], v[80:95]
    ds_read_b64_tr_b16 v[120:121], v8 offset:0
    ds_read_b64_tr_b16 v[122:123], v8 offset:512
    v_add_u32 v5, s3, v5
    v_add_u32 v6, s3, v6
    v_add_u32 v7, s3, v7
    v_mfma_f32_32x32x16_bf16 v[16:31], v[140:143], v[132:135], v[16:31]
    s_add_u32 s49, s49, 1
    v_mfma_f32_32x32x16_bf16 v[64:79], v[140:143], v[136:139], v[64:79]
    s_branch P1_loopK
P1_lastK:
    v_mfma_f32_32x32x16_bf16 v[32:47], v[132:135], v[144:147], v[32:47]
    v_mfma_f32_32x32x16_bf16 v[80:95], v[136:139], v[144:147], v[80:95]
    v_mfma_f32_32x32x16_bf16 v[16:31], v[140:143], v[132:135], v[16:31]
    v_mfma_f32_32x32x16_bf16 v[64:79], v[140:143], v[136:139], v[64:79]
    ds_read_b64 v[12:13], v3 offset:24
    s_lshl_b32 s4, s29, 11
    s_add_u32 s4, s4, 2097152
    s_add_u32 s5, s4, 131072
    s_nop 3
    v_cvt_pk_bf16_f32 v112, v48, v49
    v_cvt_pk_bf16_f32 v113, v50, v51
    v_cvt_pk_bf16_f32 v114, v52, v53
    v_cvt_pk_bf16_f32 v115, v54, v55
    v_cvt_pk_bf16_f32 v116, v56, v57
    v_cvt_pk_bf16_f32 v117, v58, v59
    v_cvt_pk_bf16_f32 v118, v60, v61
    v_cvt_pk_bf16_f32 v119, v62, v63
    v_cvt_pk_bf16_f32 v120, v96, v97
    v_cvt_pk_bf16_f32 v121, v98, v99
    v_cvt_pk_bf16_f32 v122, v100, v101
    v_cvt_pk_bf16_f32 v123, v102, v103
    v_cvt_pk_bf16_f32 v124, v104, v105
    v_cvt_pk_bf16_f32 v125, v106, v107
    v_cvt_pk_bf16_f32 v126, v108, v109
    v_cvt_pk_bf16_f32 v127, v110, v111
    buffer_store_dwordx4 v[112:115], v164, s[8:11], s4 offen offset:1024 sc1
    buffer_store_dwordx4 v[116:119], v164, s[8:11], s4 offen offset:1280 sc1
    buffer_store_dwordx4 v[120:123], v164, s[8:11], s4 offen offset:3072 sc1
    buffer_store_dwordx4 v[124:127], v164, s[8:11], s4 offen offset:3328 sc1
P1_hand:
    v_cvt_pk_bf16_f32 v136, v64, v65
    v_cvt_pk_bf16_f32 v137, v66, v67
    v_cvt_pk_bf16_f32 v138, v68, v69
    v_cvt_pk_bf16_f32 v139, v70, v71
    v_cvt_pk_bf16_f32 v140, v72, v73
    v_cvt_pk_bf16_f32 v141, v74, v75
    v_cvt_pk_bf16_f32 v142, v76, v77
    v_cvt_pk_bf16_f32 v143, v78, v79
    v_cvt_pk_bf16_f32 v144, v80, v81
    v_cvt_pk_bf16_f32 v145, v82, v83
    v_cvt_pk_bf16_f32 v146, v84, v85
    v_cvt_pk_bf16_f32 v147, v86, v87
    v_cvt_pk_bf16_f32 v148, v88, v89
    v_cvt_pk_bf16_f32 v149, v90, v91
    v_cvt_pk_bf16_f32 v150, v92, v93
    v_cvt_pk_bf16_f32 v151, v94, v95
    ds_write_b128 v11, v[136:139] offset:0
    ds_write_b128 v11, v[140:143] offset:1024
    ds_write_b128 v11, v[144:147] offset:2048
    ds_write_b128 v11, v[148:151] offset:3072
    ds_read_b64_tr_b16 v[96:97], v10 offset:0
    ds_read_b64_tr_b16 v[98:99], v10 offset:256
    ds_read_b64_tr_b16 v[100:101], v10 offset:512
    ds_read_b64_tr_b16 v[102:103], v10 offset:768
    v_cvt_pk_bf16_f32 v64, v16, v17
    v_cvt_pk_bf16_f32 v65, v18, v19
    v_cvt_pk_bf16_f32 v66, v20, v21
    v_cvt_pk_bf16_f32 v67, v22, v23
    v_cvt_pk_bf16_f32 v68, v24, v25
    v_cvt_pk_bf16_f32 v69, v26, v27
    v_cvt_pk_bf16_f32 v70, v28, v29
    v_cvt_pk_bf16_f32 v71, v30, v31
    v_cvt_pk_bf16_f32 v72, v32, v33
    v_cvt_pk_bf16_f32 v73, v34, v35
    v_cvt_pk_bf16_f32 v74, v36, v37
    v_cvt_pk_bf16_f32 v75, v38, v39
    v_cvt_pk_bf16_f32 v76, v40, v41
    v_cvt_pk_bf16_f32 v77, v42, v43
    v_cvt_pk_bf16_f32 v78, v44, v45
    v_cvt_pk_bf16_f32 v79, v46, v47
    s_waitcnt lgkmcnt(0)
    v_readfirstlane_b32 s34, v12
    v_readfirstlane_b32 s35, v13
    v_mov_b32 v12, 1
    s_mov_b64 exec, 1
    ds_add_u32 v3, v12 offset:64
    s_mov_b64 exec, -1
    s_waitcnt vmcnt(0)
    v_mov_b32 v6, 1
    s_mov_b64 exec, 1
    ds_add_rtn_u32 v6, v3, v6 offset:32
    s_waitcnt lgkmcnt(0)
    v_readfirstlane_b32 s3, v6
    s_mov_b64 exec, -1
    s_cmp_lg_u32 s3, 3
    s_cbranch_scc1 P1_nofl1
    v_mov_b32 v6, s34
    v_mov_b32 v7, s35
    v_mov_b32 v8, 0
    s_mov_b64 exec, 1
    buffer_store_dwordx2 v[6:7], v8, s[8:11], s63 offen sc1
    s_mov_b64 exec, -1
P1_nofl1:
    s_cmp_eq_u32 s38, 0
    s_cbranch_scc1 P1_feat
    s_mov_b32 s30, 0x3eb8aa3b
    s_mov_b32 s31, s30
    s_lshl_b32 s4, s29, 10
    s_add_u32 s5, s4, 65536
    v_pk_mul_f32 v[32:33], v[32:33], s[30:31]
    v_pk_mul_f32 v[34:35], v[34:35], s[30:31]
    v_pk_mul_f32 v[36:37], v[36:37], s[30:31]
    v_pk_mul_f32 v[38:39], v[38:39], s[30:31]
    v_pk_mul_f32 v[40:41], v[40:41], s[30:31]
    v_pk_mul_f32 v[42:43], v[42:43], s[30:31]
    v_pk_mul_f32 v[44:45], v[44:45], s[30:31]
    v_pk_mul_f32 v[46:47], v[46:47], s[30:31]
    v_cvt_pk_bf16_f32 v16, v32, v33
    v_cvt_pk_bf16_f32 v17, v34, v35
    v_cvt_pk_bf16_f32 v18, v36, v37
    v_cvt_pk_bf16_f32 v19, v38, v39
    v_cvt_pk_bf16_f32 v20, v40, v41
    v_cvt_pk_bf16_f32 v21, v42, v43
    v_cvt_pk_bf16_f32 v22, v44, v45
    v_cvt_pk_bf16_f32 v23, v46, v47
    buffer_store_dwordx4 v[16:19], v9, s[8:11], s4 offen offset:0 sc1
    buffer_store_dwordx4 v[20:23], v9, s[8:11], s5 offen offset:0 sc1
    v_pk_mul_f32 v[80:81], v[80:81], s[30:31]
    v_pk_mul_f32 v[82:83], v[82:83], s[30:31]
    v_pk_mul_f32 v[84:85], v[84:85], s[30:31]
    v_pk_mul_f32 v[86:87], v[86:87], s[30:31]
    v_pk_mul_f32 v[88:89], v[88:89], s[30:31]
    v_pk_mul_f32 v[90:91], v[90:91], s[30:31]
    v_pk_mul_f32 v[92:93], v[92:93], s[30:31]
    v_pk_mul_f32 v[94:95], v[94:95], s[30:31]
    v_cvt_pk_bf16_f32 v24, v80, v81
    v_cvt_pk_bf16_f32 v25, v82, v83
    v_cvt_pk_bf16_f32 v26, v84, v85
    v_cvt_pk_bf16_f32 v27, v86, v87
    v_cvt_pk_bf16_f32 v28, v88, v89
    v_cvt_pk_bf16_f32 v29, v90, v91
    v_cvt_pk_bf16_f32 v30, v92, v93
    v_cvt_pk_bf16_f32 v31, v94, v95
    buffer_store_dwordx4 v[24:27], v9, s[8:11], s4 offen offset:1024 sc1
    buffer_store_dwordx4 v[28:31], v9, s[8:11], s5 offen offset:1024 sc1
P1_feat:
    v_mov_b64 v[88:89], v[152:153]
    v_mov_b64 v[90:91], v[154:155]
    v_mov_b64 v[92:93], v[156:157]
    v_mov_b64 v[94:95], v[158:159]
    v_mov_b64 v[56:57], v[160:161]
    v_mov_b64 v[58:59], v[162:163]
    s_mov_b32 s30, 0x3fb8aa3b
    s_mov_b32 s31, s30
    v_mfma_f32_32x32x16_bf16 v[104:119], v[96:99], v[64:67], 0
    v_mfma_f32_32x32x16_bf16 v[120:135], v[100:103], v[68:71], 0
    s_nop 7
    s_nop 2
    v_max3_f32 v10, v104, v105, v106
    v_min3_f32 v12, v104, v105, v106
    v_max3_f32 v14, v120, v121, v122
    v_min3_f32 v4, v120, v121, v122
    v_max3_f32 v10, v10, v107, v108
    v_min3_f32 v12, v12, v107, v108
    v_max3_f32 v14, v14, v123, v124
    v_min3_f32 v4, v4, v123, v124
    v_max3_f32 v10, v10, v109, v110
    v_min3_f32 v12, v12, v109, v110
    v_max3_f32 v14, v14, v125, v126
    v_min3_f32 v4, v4, v125, v126
    v_max_f32 v10, v10, v111
    v_min_f32 v12, v12, v111
    v_max_f32 v14, v14, v127
    v_min_f32 v4, v4, v127
    v_mov_b32 v11, v10
    v_mov_b32 v13, v12
    v_mov_b32 v15, v14
    v_mov_b32 v5, v4
    s_nop 1
    v_permlane32_swap_b32 v10, v11
    v_permlane32_swap_b32 v12, v13
    v_permlane32_swap_b32 v14, v15
    v_permlane32_swap_b32 v4, v5
    s_nop 1
    v_max_f32 v10, v10, v11
    v_min_f32 v12, v12, v13
    v_max_f32 v14, v14, v15
    v_min_f32 v4, v4, v5
    v_mul_f32 v10, s30, v10
    v_mul_f32 v12, s30, v12
    v_mul_f32 v14, s30, v14
    v_mul_f32 v4, s30, v4
    v_pk_fma_f32 v[136:137], v[104:105], s[30:31], v[10:11] op_sel_hi:[1,1,0] neg_lo:[0,0,1] neg_hi:[0,0,1]
    v_pk_fma_f32 v[144:145], v[104:105], s[30:31], v[12:13] op_sel_hi:[1,1,0] neg_lo:[1,0,0] neg_hi:[1,0,0]
    v_pk_fma_f32 v[152:153], v[120:121], s[30:31], v[14:15] op_sel_hi:[1,1,0] neg_lo:[0,0,1] neg_hi:[0,0,1]
    v_pk_fma_f32 v[160:161], v[120:121], s[30:31], v[4:5] op_sel_hi:[1,1,0] neg_lo:[1,0,0] neg_hi:[1,0,0]
    v_pk_fma_f32 v[138:139], v[106:107], s[30:31], v[10:11] op_sel_hi:[1,1,0] neg_lo:[0,0,1] neg_hi:[0,0,1]
    v_pk_fma_f32 v[146:147], v[106:107], s[30:31], v[12:13] op_sel_hi:[1,1,0] neg_lo:[1,0,0] neg_hi:[1,0,0]
    v_pk_fma_f32 v[154:155], v[122:123], s[30:31], v[14:15] op_sel_hi:[1,1,0] neg_lo:[0,0,1] neg_hi:[0,0,1]
    v_pk_fma_f32 v[162:163], v[122:123], s[30:31], v[4:5] op_sel_hi:[1,1,0] neg_lo:[1,0,0] neg_hi:[1,0,0]
    v_pk_fma_f32 v[140:141], v[108:109], s[30:31], v[10:11] op_sel_hi:[1,1,0] neg_lo:[0,0,1] neg_hi:[0,0,1]
    v_pk_fma_f32 v[148:149], v[108:109], s[30:31], v[12:13] op_sel_hi:[1,1,0] neg_lo:[1,0,0] neg_hi:[1,0,0]
    v_pk_fma_f32 v[156:157], v[124:125], s[30:31], v[14:15] op_sel_hi:[1,1,0] neg_lo:[0,0,1] neg_hi:[0,0,1]
    v_pk_fma_f32 v[164:165], v[124:125], s[30:31], v[4:5] op_sel_hi:[1,1,0] neg_lo:[1,0,0] neg_hi:[1,0,0]
    v_pk_fma_f32 v[142:143], v[110:111], s[30:31], v[10:11] op_sel_hi:[1,1,0] neg_lo:[0,0,1] neg_hi:[0,0,1]
    v_pk_fma_f32 v[150:151], v[110:111], s[30:31], v[12:13] op_sel_hi:[1,1,0] neg_lo:[1,0,0] neg_hi:[1,0,0]
    v_pk_fma_f32 v[158:159], v[126:127], s[30:31], v[14:15] op_sel_hi:[1,1,0] neg_lo:[0,0,1] neg_hi:[0,0,1]
    v_pk_fma_f32 v[166:167], v[126:127], s[30:31], v[4:5] op_sel_hi:[1,1,0] neg_lo:[1,0,0] neg_hi:[1,0,0]
    v_exp_f32 v136, v136
    v_exp_f32 v152, v152
    v_exp_f32 v137, v137
    v_exp_f32 v153, v153
    v_exp_f32 v138, v138
    v_exp_f32 v154, v154
    v_exp_f32 v139, v139
    v_exp_f32 v155, v155
    v_exp_f32 v140, v140
    v_exp_f32 v156, v156
    v_exp_f32 v141, v141
    v_exp_f32 v157, v157
    v_exp_f32 v142, v142
    v_exp_f32 v158, v158
    v_exp_f32 v143, v143
    v_exp_f32 v159, v159
    v_exp_f32 v144, v144
    v_exp_f32 v160, v160
    v_exp_f32 v145, v145
    v_exp_f32 v161, v161
    v_exp_f32 v146, v146
    v_exp_f32 v162, v162
    v_exp_f32 v147, v147
    v_exp_f32 v163, v163
    v_exp_f32 v148, v148
    v_exp_f32 v164, v164
    v_exp_f32 v149, v149
    v_exp_f32 v165, v165
    v_exp_f32 v150, v150
    v_exp_f32 v166, v166
    v_exp_f32 v151, v151
    v_exp_f32 v167, v167
    v_pk_add_f32 v[104:105], v[136:137], v[138:139]
    v_pk_add_f32 v[106:107], v[140:141], v[142:143]
    v_pk_add_f32 v[108:109], v[144:145], v[146:147]
    v_pk_add_f32 v[110:111], v[148:149], v[150:151]
    v_pk_add_f32 v[120:121], v[152:153], v[154:155]
    v_pk_add_f32 v[122:123], v[156:157], v[158:159]
    v_pk_add_f32 v[124:125], v[160:161], v[162:163]
    v_pk_add_f32 v[126:127], v[164:165], v[166:167]
    v_pk_add_f32 v[104:105], v[104:105], v[106:107]
    v_pk_add_f32 v[108:109], v[108:109], v[110:111]
    v_pk_add_f32 v[120:121], v[120:121], v[122:123]
    v_pk_add_f32 v[124:125], v[124:125], v[126:127]
    v_add_f32 v10, v104, v105
    v_add_f32 v12, v108, v109
    v_add_f32 v14, v120, v121
    v_add_f32 v4, v124, v125
    v_mov_b32 v11, v10
    v_mov_b32 v13, v12
    v_mov_b32 v15, v14
    v_mov_b32 v5, v4
    s_nop 1
    v_permlane32_swap_b32 v10, v11
    v_permlane32_swap_b32 v12, v13
    v_permlane32_swap_b32 v14, v15
    v_permlane32_swap_b32 v4, v5
    s_nop 1
    v_add_f32 v10, v10, v11
    v_add_f32 v12, v12, v13
    v_add_f32 v14, v14, v15
    v_add_f32 v4, v4, v5
    v_rcp_f32 v10, v10
    v_rcp_f32 v12, v12
    v_rcp_f32 v14, v14
    v_rcp_f32 v4, v4
    s_nop 0
    v_pk_mul_f32 v[136:137], v[136:137], v[10:11] op_sel_hi:[1,0]
    v_pk_mul_f32 v[144:145], v[144:145], v[12:13] op_sel_hi:[1,0]
    v_pk_mul_f32 v[152:153], v[152:153], v[14:15] op_sel_hi:[1,0]
    v_pk_mul_f32 v[160:161], v[160:161], v[4:5] op_sel_hi:[1,0]
    v_pk_mul_f32 v[138:139], v[138:139], v[10:11] op_sel_hi:[1,0]
    v_pk_mul_f32 v[146:147], v[146:147], v[12:13] op_sel_hi:[1,0]
    v_pk_mul_f32 v[154:155], v[154:155], v[14:15] op_sel_hi:[1,0]
    v_pk_mul_f32 v[162:163], v[162:163], v[4:5] op_sel_hi:[1,0]
    v_pk_mul_f32 v[140:141], v[140:141], v[10:11] op_sel_hi:[1,0]
    v_pk_mul_f32 v[148:149], v[148:149], v[12:13] op_sel_hi:[1,0]
    v_pk_mul_f32 v[156:157], v[156:157], v[14:15] op_sel_hi:[1,0]
    v_pk_mul_f32 v[164:165], v[164:165], v[4:5] op_sel_hi:[1,0]
    v_pk_mul_f32 v[142:143], v[142:143], v[10:11] op_sel_hi:[1,0]
    v_pk_mul_f32 v[150:151], v[150:151], v[12:13] op_sel_hi:[1,0]
    v_pk_mul_f32 v[158:159], v[158:159], v[14:15] op_sel_hi:[1,0]
    v_pk_mul_f32 v[166:167], v[166:167], v[4:5] op_sel_hi:[1,0]
    v_cvt_pk_bf16_f32 v112, v136, v137
    v_cvt_pk_bf16_f32 v128, v152, v153
    v_cvt_pk_bf16_f32 v113, v138, v139
    v_cvt_pk_bf16_f32 v129, v154, v155
    v_cvt_pk_bf16_f32 v114, v140, v141
    v_cvt_pk_bf16_f32 v130, v156, v157
    v_cvt_pk_bf16_f32 v115, v142, v143
    v_cvt_pk_bf16_f32 v131, v158, v159
    v_cvt_pk_bf16_f32 v116, v144, v145
    v_cvt_pk_bf16_f32 v132, v160, v161
    v_cvt_pk_bf16_f32 v117, v146, v147
    v_cvt_pk_bf16_f32 v133, v162, v163
    v_cvt_pk_bf16_f32 v118, v148, v149
    v_cvt_pk_bf16_f32 v134, v164, v165
    v_cvt_pk_bf16_f32 v119, v150, v151
    v_cvt_pk_bf16_f32 v135, v166, v167
    s_cmp_eq_u32 s38, 0
    s_cbranch_scc1 P1_featK
    s_lshl_b32 s4, s29, 11
    s_add_u32 s4, s4, 6291456
    s_add_u32 s5, s4, 131072
    s_cmp_ge_u32 s12, 4
    s_cbranch_scc1 P1_done
    s_waitcnt vmcnt(0)
    v_mov_b32 v6, 1
    s_mov_b64 exec, 1
    ds_add_rtn_u32 v6, v3, v6 offset:68
    s_waitcnt lgkmcnt(0)
    v_readfirstlane_b32 s3, v6
    s_mov_b64 exec, -1
    s_cmp_lg_u32 s3, 3
    s_cbranch_scc1 P1_done
    v_mov_b32 v6, s34
    v_mov_b32 v7, s35
    v_mov_b32 v8, 0
    s_mov_b64 exec, 1
    buffer_store_dwordx2 v[6:7], v8, s[8:11], s39 offen sc1
    s_mov_b64 exec, -1
    s_branch P1_done
P1_featK:
    v_mov_b32 v15, 0x3f803f80
    v_mfma_f32_32x32x16_bf16 v[16:31], v[112:115], v[88:91], 0
    v_mfma_f32_32x32x16_bf16 v[16:31], v[116:119], v[92:95], v[16:31]
    v_mfma_f32_32x32x16_bf16 v[32:47], v[128:131], v[88:91], 0
    v_mfma_f32_32x32x16_bf16 v[32:47], v[132:135], v[92:95], v[32:47]
    v_cndmask_b32 v96, v72, v15, s[6:7]
    v_cndmask_b32 v64, v15, v72, s[6:7]
    v_cndmask_b32 v97, v73, v15, s[6:7]
    v_cndmask_b32 v65, v15, v73, s[6:7]
    v_cndmask_b32 v98, v74, v15, s[6:7]
    v_cndmask_b32 v66, v15, v74, s[6:7]
    v_cndmask_b32 v99, v75, v15, s[6:7]
    v_cndmask_b32 v67, v15, v75, s[6:7]
    v_cndmask_b32 v100, v76, v15, s[6:7]
    v_cndmask_b32 v68, v15, v76, s[6:7]
    v_cndmask_b32 v101, v77, v15, s[6:7]
    v_cndmask_b32 v69, v15, v77, s[6:7]
    v_cndmask_b32 v102, v78, v15, s[6:7]
    v_cndmask_b32 v70, v15, v78, s[6:7]
    v_cndmask_b32 v103, v79, v15, s[6:7]
    v_cndmask_b32 v71, v15, v79, s[6:7]
    v_cvt_pk_bf16_f32 v104, v16, v17
    v_cvt_pk_bf16_f32 v105, v18, v19
    v_cvt_pk_bf16_f32 v106, v20, v21
    v_cvt_pk_bf16_f32 v107, v22, v23
    v_cvt_pk_bf16_f32 v108, v24, v25
    v_cvt_pk_bf16_f32 v109, v26, v27
    v_cvt_pk_bf16_f32 v110, v28, v29
    v_cvt_pk_bf16_f32 v111, v30, v31
    v_cvt_pk_bf16_f32 v120, v32, v33
    v_cvt_pk_bf16_f32 v121, v34, v35
    v_cvt_pk_bf16_f32 v122, v36, v37
    v_cvt_pk_bf16_f32 v123, v38, v39
    v_cvt_pk_bf16_f32 v124, v40, v41
    v_cvt_pk_bf16_f32 v125, v42, v43
    v_cvt_pk_bf16_f32 v126, v44, v45
    v_cvt_pk_bf16_f32 v127, v46, v47
    s_nop 1
    v_mfma_f32_32x32x16_bf16 v[136:151], v[104:107], v[96:99], 0
    v_mfma_f32_32x32x16_bf16 v[136:151], v[108:111], v[100:103], v[136:151]
    v_mfma_f32_32x32x16_bf16 v[152:167], v[120:123], v[64:67], 0
    v_mfma_f32_32x32x16_bf16 v[152:167], v[124:127], v[68:71], v[152:167]
    s_nop 7
    s_nop 1
    ds_write_b128 v56, v[136:139] offset:0
    ds_write_b128 v56, v[140:143] offset:1024
    ds_write_b128 v56, v[144:147] offset:2048
    ds_write_b128 v56, v[148:151] offset:3072
    ds_write_b128 v56, v[152:155] offset:4096
    ds_write_b128 v56, v[156:159] offset:5120
    ds_write_b128 v56, v[160:163] offset:6144
    ds_write_b128 v56, v[164:167] offset:7168
    s_waitcnt lgkmcnt(0)
    v_mov_b32 v10, 1
    s_mov_b64 exec, 1
    ds_add_u32 v3, v10 offset:40
    s_mov_b64 exec, -1
Lp45:
    ds_read_b32 v10, v3 offset:40
    s_waitcnt lgkmcnt(0)
    v_readfirstlane_b32 s3, v10
    s_cmp_ge_u32 s3, 8
    s_cbranch_scc1 Lq46
    s_sleep 1
    s_branch Lp45
Lq46:
    ds_read_b128 v[16:19], v57 offset:0
    ds_read_b128 v[20:23], v57 offset:1024
    ds_read_b128 v[24:27], v57 offset:8192
    ds_read_b128 v[28:31], v57 offset:9216
    ds_read_b128 v[32:35], v57 offset:16384
    ds_read_b128 v[36:39], v57 offset:17408
    ds_read_b128 v[40:43], v57 offset:24576
    ds_read_b128 v[44:47], v57 offset:25600
    s_waitcnt lgkmcnt(0)
    v_mov_b32 v10, 1
    s_mov_b64 exec, 1
    ds_add_u32 v3, v10 offset:44
    s_mov_b64 exec, -1
    v_pk_add_f32 v[16:17], v[16:17], v[24:25]
    v_pk_add_f32 v[32:33], v[32:33], v[40:41]
    v_pk_add_f32 v[18:19], v[18:19], v[26:27]
    v_pk_add_f32 v[34:35], v[34:35], v[42:43]
    v_pk_add_f32 v[20:21], v[20:21], v[28:29]
    v_pk_add_f32 v[36:37], v[36:37], v[44:45]
    v_pk_add_f32 v[22:23], v[22:23], v[30:31]
    v_pk_add_f32 v[38:39], v[38:39], v[46:47]
    v_pk_add_f32 v[136:137], v[16:17], v[32:33]
    v_pk_add_f32 v[138:139], v[18:19], v[34:35]
    v_pk_add_f32 v[140:141], v[20:21], v[36:37]
    v_pk_add_f32 v[142:143], v[22:23], v[38:39]
P1_done:
    v_mov_b64 v[144:145], v[58:59]
    s_mov_b32 s63, s38
    v_mov_b32 v108, v3
    v_mov_b32 v1, v9
    s_and_b32 s38, s2, 7
    s_lshl_b32 s13, s38, 2
    s_lshr_b32 s3, s2, 3
    s_and_b32 s36, s3, 3
    s_lshr_b32 s37, s3, 2
    s_add_u32 s13, s13, s36
    s_mov_b32 s36, s13
    s_lshr_b32 s14, s2, 5
    s_lshl_b32 s15, s14, 3
    s_add_u32 s15, s15, s12
    s_lshl_b32 s16, s13, 6
    s_add_u32 s16, s16, s15
    v_and_b32 v2, 27, v0
    v_cmp_eq_u32 s[24:25], 16, v2
    v_mov_b32 v3, 0x3f803f80
    s_mov_b32 s20, 0x0000ffff
    s_mov_b32 s21, 0x0000ffff
    v_cndmask_b32 v16, 0, v3, s[24:25]
    v_mov_b32 v17, v16
    v_mov_b32 v18, v16
    v_mov_b32 v19, v16
    v_mov_b32 v20, v16
    v_mov_b32 v21, v16
    v_mov_b32 v22, v16
    v_mov_b32 v23, v16
    v_mov_b32 v24, v16
    v_mov_b32 v25, v16
    v_mov_b32 v26, v16
    v_mov_b32 v27, v16
    v_mov_b32 v28, v16
    v_mov_b32 v29, v16
    v_mov_b32 v30, v16
    v_mov_b32 v31, v16
    s_mov_b32 s22, 0
    s_mov_b32 s29, 0x1ae
    s_lshl_b32 s47, s12, 18
    s_lshl_b32 s3, s36, 11
    s_add_u32 s47, s47, s3
    s_add_u32 s47, s47, 14680064
Lp47:
    ds_read_b32 v104, v108 offset:72
    s_waitcnt lgkmcnt(0)
    v_readfirstlane_b32 s3, v104
    s_cmp_ge_u32 s3, 1
    s_cbranch_scc1 Lq48
    s_sleep 1
    s_branch Lp47
Lq48:
    s_lshl_b32 s19, s16, 10
    buffer_load_dwordx4 v[4:7], v1, s[8:11], s19 offen sc1
Lp49:
    ds_read_b32 v104, v108 offset:52
    s_waitcnt lgkmcnt(0)
    v_readfirstlane_b32 s3, v104
    s_cmp_ge_u32 s3, 4
    s_cbranch_scc1 Lq50
    s_sleep 1
    s_branch Lp49
Lq50:
    s_setprio 3
    ds_read_b128 v[8:11], v1
    s_waitcnt vmcnt(0) lgkmcnt(0)
    v_mfma_f32_32x32x16_bf16 v[88:103], v[8:11], v[4:7], 0
    s_nop 7
    s_nop 3
    v_max3_f32 v2, v88, v89, v90
    v_max3_f32 v2, v2, v91, v92
    v_max3_f32 v2, v2, v93, v94
    v_max3_f32 v2, v2, v95, v96
    v_max3_f32 v2, v2, v97, v98
    v_max3_f32 v2, v2, v99, v100
    v_max3_f32 v2, v2, v101, v102
    v_max_f32 v2, v2, v103
    v_mov_b32 v3, v2
    s_nop 1
    v_permlane32_swap_b32 v2, v3
    s_nop 1
    v_max_f32 v2, v2, v3
P2_restart:
    v_mov_b32 v3, v1
    ds_read_b128 v[8:11], v3
    ds_read_b128 v[12:15], v3 offset:2048
    s_mov_b64 exec, s[20:21]
    ds_read_b128 v[16:19], v3 offset:1024
    ds_read_b128 v[20:23], v3 offset:1280
    s_mov_b64 exec, -1
    v_sub_f32 v56, 0, v2
    v_sub_f32 v57, 0, v2
    v_mov_b64 v[58:59], v[56:57]
    v_mov_b64 v[60:61], v[56:57]
    v_mov_b64 v[62:63], v[56:57]
    v_mov_b64 v[64:65], v[56:57]
    v_mov_b64 v[66:67], v[56:57]
    v_mov_b64 v[68:69], v[56:57]
    v_mov_b64 v[70:71], v[56:57]
    v_mov_b64 v[40:41], 0
    v_mov_b64 v[42:43], 0
    v_mov_b64 v[44:45], 0
    v_mov_b64 v[46:47], 0
    v_mov_b64 v[48:49], 0
    v_mov_b64 v[50:51], 0
    v_mov_b64 v[52:53], 0
    v_mov_b64 v[54:55], 0
    s_waitcnt lgkmcnt(3)
    v_mfma_f32_32x32x16_bf16 v[72:87], v[8:11], v[4:7], v[56:71]
    s_mov_b32 s23, 0
    s_nop 7
    s_nop 3
    .p2align 3
P2_loop:
    v_exp_f32 v72, v72
    v_exp_f32 v73, v73
    v_exp_f32 v74, v74
    v_exp_f32 v75, v75
    s_waitcnt lgkmcnt(0)
    v_mfma_f32_32x32x16_bf16 v[88:103], v[12:15], v[4:7], v[56:71]
    ds_read_b128 v[8:11], v3 offset:4096
    v_exp_f32 v76, v76
    v_exp_f32 v77, v77
    v_exp_f32 v78, v78
    v_exp_f32 v79, v79
    v_cvt_pk_bf16_f32 v32, v72, v73
    v_cvt_pk_bf16_f32 v33, v74, v75
    v_cvt_pk_bf16_f32 v34, v76, v77
    v_cvt_pk_bf16_f32 v35, v78, v79
    v_exp_f32 v80, v80
    v_exp_f32 v81, v81
    v_mfma_f32_32x32x16_bf16 v[40:55], v[16:19], v[32:35], v[40:55]
    s_mov_b64 exec, s[20:21]
    ds_read_b128 v[24:27], v3 offset:3072
    ds_read_b128 v[28:31], v3 offset:3328
    s_mov_b64 exec, -1
    v_exp_f32 v82, v82
    v_exp_f32 v83, v83
    v_exp_f32 v84, v84
    v_exp_f32 v85, v85
    v_exp_f32 v86, v86
    v_exp_f32 v87, v87
    v_cvt_pk_bf16_f32 v36, v80, v81
    v_cvt_pk_bf16_f32 v37, v82, v83
    v_cvt_pk_bf16_f32 v38, v84, v85
    v_cvt_pk_bf16_f32 v39, v86, v87
    s_nop 1
    v_mfma_f32_32x32x16_bf16 v[40:55], v[20:23], v[36:39], v[40:55]
    v_exp_f32 v88, v88
    v_exp_f32 v89, v89
    v_exp_f32 v90, v90
    v_exp_f32 v91, v91
    s_waitcnt lgkmcnt(0)
    v_mfma_f32_32x32x16_bf16 v[72:87], v[8:11], v[4:7], v[56:71]
    ds_read_b128 v[12:15], v3 offset:6144
    v_exp_f32 v92, v92
    v_exp_f32 v93, v93
    v_exp_f32 v94, v94
    v_exp_f32 v95, v95
    v_cvt_pk_bf16_f32 v32, v88, v89
    v_cvt_pk_bf16_f32 v33, v90, v91
    v_cvt_pk_bf16_f32 v34, v92, v93
    v_cvt_pk_bf16_f32 v35, v94, v95
    v_exp_f32 v96, v96
    v_exp_f32 v97, v97
    v_mfma_f32_32x32x16_bf16 v[40:55], v[24:27], v[32:35], v[40:55]
    s_mov_b64 exec, s[20:21]
    ds_read_b128 v[16:19], v3 offset:5120
    ds_read_b128 v[20:23], v3 offset:5376
    s_mov_b64 exec, -1
    v_exp_f32 v98, v98
    v_exp_f32 v99, v99
    v_exp_f32 v100, v100
    v_exp_f32 v101, v101
    v_exp_f32 v102, v102
    v_exp_f32 v103, v103
    v_cvt_pk_bf16_f32 v36, v96, v97
    v_cvt_pk_bf16_f32 v37, v98, v99
    v_cvt_pk_bf16_f32 v38, v100, v101
    v_cvt_pk_bf16_f32 v39, v102, v103
    s_nop 1
    v_mfma_f32_32x32x16_bf16 v[40:55], v[28:31], v[36:39], v[40:55]
    v_exp_f32 v72, v72
    v_exp_f32 v73, v73
    v_exp_f32 v74, v74
    v_exp_f32 v75, v75
    s_waitcnt lgkmcnt(0)
    v_mfma_f32_32x32x16_bf16 v[88:103], v[12:15], v[4:7], v[56:71]
    ds_read_b128 v[8:11], v3 offset:8192
    v_exp_f32 v76, v76
    v_exp_f32 v77, v77
    v_exp_f32 v78, v78
    v_exp_f32 v79, v79
    v_cvt_pk_bf16_f32 v32, v72, v73
    v_cvt_pk_bf16_f32 v33, v74, v75
    v_cvt_pk_bf16_f32 v34, v76, v77
    v_cvt_pk_bf16_f32 v35, v78, v79
    v_exp_f32 v80, v80
    v_exp_f32 v81, v81
    v_mfma_f32_32x32x16_bf16 v[40:55], v[16:19], v[32:35], v[40:55]
    s_mov_b64 exec, s[20:21]
    ds_read_b128 v[24:27], v3 offset:7168
    ds_read_b128 v[28:31], v3 offset:7424
    s_mov_b64 exec, -1
    v_exp_f32 v82, v82
    v_exp_f32 v83, v83
    v_exp_f32 v84, v84
    v_exp_f32 v85, v85
    v_exp_f32 v86, v86
    v_exp_f32 v87, v87
    v_cvt_pk_bf16_f32 v36, v80, v81
    v_cvt_pk_bf16_f32 v37, v82, v83
    v_cvt_pk_bf16_f32 v38, v84, v85
    v_cvt_pk_bf16_f32 v39, v86, v87
    s_nop 1
    v_mfma_f32_32x32x16_bf16 v[40:55], v[20:23], v[36:39], v[40:55]
    v_exp_f32 v88, v88
    v_exp_f32 v89, v89
    v_exp_f32 v90, v90
    v_exp_f32 v91, v91
    s_waitcnt lgkmcnt(0)
    v_mfma_f32_32x32x16_bf16 v[72:87], v[8:11], v[4:7], v[56:71]
    ds_read_b128 v[12:15], v3 offset:10240
    v_exp_f32 v92, v92
    v_exp_f32 v93, v93
    v_exp_f32 v94, v94
    v_exp_f32 v95, v95
    v_cvt_pk_bf16_f32 v32, v88, v89
    v_cvt_pk_bf16_f32 v33, v90, v91
    v_cvt_pk_bf16_f32 v34, v92, v93
    v_cvt_pk_bf16_f32 v35, v94, v95
    v_exp_f32 v96, v96
    v_exp_f32 v97, v97
    v_mfma_f32_32x32x16_bf16 v[40:55], v[24:27], v[32:35], v[40:55]
    s_mov_b64 exec, s[20:21]
    ds_read_b128 v[16:19], v3 offset:9216
    ds_read_b128 v[20:23], v3 offset:9472
    s_mov_b64 exec, -1
    v_exp_f32 v98, v98
    v_exp_f32 v99, v99
    v_exp_f32 v100, v100
    v_exp_f32 v101, v101
    v_exp_f32 v102, v102
    v_exp_f32 v103, v103
    v_cvt_pk_bf16_f32 v36, v96, v97
    v_cvt_pk_bf16_f32 v37, v98, v99
    v_cvt_pk_bf16_f32 v38, v100, v101
    v_cvt_pk_bf16_f32 v39, v102, v103
    s_nop 1
    v_mfma_f32_32x32x16_bf16 v[40:55], v[28:31], v[36:39], v[40:55]
    v_exp_f32 v72, v72
    v_exp_f32 v73, v73
    v_exp_f32 v74, v74
    v_exp_f32 v75, v75
    s_waitcnt lgkmcnt(0)
    v_mfma_f32_32x32x16_bf16 v[88:103], v[12:15], v[4:7], v[56:71]
    ds_read_b128 v[8:11], v3 offset:12288
    v_exp_f32 v76, v76
    v_exp_f32 v77, v77
    v_exp_f32 v78, v78
    v_exp_f32 v79, v79
    v_cvt_pk_bf16_f32 v32, v72, v73
    v_cvt_pk_bf16_f32 v33, v74, v75
    v_cvt_pk_bf16_f32 v34, v76, v77
    v_cvt_pk_bf16_f32 v35, v78, v79
    v_exp_f32 v80, v80
    v_exp_f32 v81, v81
    v_mfma_f32_32x32x16_bf16 v[40:55], v[16:19], v[32:35], v[40:55]
    s_mov_b64 exec, s[20:21]
    ds_read_b128 v[24:27], v3 offset:11264
    ds_read_b128 v[28:31], v3 offset:11520
    s_mov_b64 exec, -1
    v_exp_f32 v82, v82
    v_exp_f32 v83, v83
    v_exp_f32 v84, v84
    v_exp_f32 v85, v85
    v_exp_f32 v86, v86
    v_exp_f32 v87, v87
    v_cvt_pk_bf16_f32 v36, v80, v81
    v_cvt_pk_bf16_f32 v37, v82, v83
    v_cvt_pk_bf16_f32 v38, v84, v85
    v_cvt_pk_bf16_f32 v39, v86, v87
    s_nop 1
    v_mfma_f32_32x32x16_bf16 v[40:55], v[20:23], v[36:39], v[40:55]
    v_exp_f32 v88, v88
    v_exp_f32 v89, v89
    v_exp_f32 v90, v90
    v_exp_f32 v91, v91
    s_waitcnt lgkmcnt(0)
    v_mfma_f32_32x32x16_bf16 v[72:87], v[8:11], v[4:7], v[56:71]
    ds_read_b128 v[12:15], v3 offset:14336
    v_exp_f32 v92, v92
    v_exp_f32 v93, v93
    v_exp_f32 v94, v94
    v_exp_f32 v95, v95
    v_cvt_pk_bf16_f32 v32, v88, v89
    v_cvt_pk_bf16_f32 v33, v90, v91
    v_cvt_pk_bf16_f32 v34, v92, v93
    v_cvt_pk_bf16_f32 v35, v94, v95
    v_exp_f32 v96, v96
    v_exp_f32 v97, v97
    v_mfma_f32_32x32x16_bf16 v[40:55], v[24:27], v[32:35], v[40:55]
    s_mov_b64 exec, s[20:21]
    ds_read_b128 v[16:19], v3 offset:13312
    ds_read_b128 v[20:23], v3 offset:13568
    s_mov_b64 exec, -1
    v_exp_f32 v98, v98
    v_exp_f32 v99, v99
    v_exp_f32 v100, v100
    v_exp_f32 v101, v101
    v_exp_f32 v102, v102
    v_exp_f32 v103, v103
    v_cvt_pk_bf16_f32 v36, v96, v97
    v_cvt_pk_bf16_f32 v37, v98, v99
    v_cvt_pk_bf16_f32 v38, v100, v101
    v_cvt_pk_bf16_f32 v39, v102, v103
    s_nop 1
    v_mfma_f32_32x32x16_bf16 v[40:55], v[28:31], v[36:39], v[40:55]
    v_exp_f32 v72, v72
    v_exp_f32 v73, v73
    v_exp_f32 v74, v74
    v_exp_f32 v75, v75
    s_waitcnt lgkmcnt(0)
    v_mfma_f32_32x32x16_bf16 v[88:103], v[12:15], v[4:7], v[56:71]
    ds_read_b128 v[8:11], v3 offset:16384
    v_exp_f32 v76, v76
    v_exp_f32 v77, v77
    v_exp_f32 v78, v78
    v_exp_f32 v79, v79
    v_cvt_pk_bf16_f32 v32, v72, v73
    v_cvt_pk_bf16_f32 v33, v74, v75
    v_cvt_pk_bf16_f32 v34, v76, v77
    v_cvt_pk_bf16_f32 v35, v78, v79
    v_exp_f32 v80, v80
    v_exp_f32 v81, v81
    v_mfma_f32_32x32x16_bf16 v[40:55], v[16:19], v[32:35], v[40:55]
    s_mov_b64 exec, s[20:21]
    ds_read_b128 v[24:27], v3 offset:15360
    ds_read_b128 v[28:31], v3 offset:15616
    s_mov_b64 exec, -1
    v_exp_f32 v82, v82
    v_exp_f32 v83, v83
    v_exp_f32 v84, v84
    v_exp_f32 v85, v85
    v_exp_f32 v86, v86
    v_exp_f32 v87, v87
    v_cvt_pk_bf16_f32 v36, v80, v81
    v_cvt_pk_bf16_f32 v37, v82, v83
    v_cvt_pk_bf16_f32 v38, v84, v85
    v_cvt_pk_bf16_f32 v39, v86, v87
    s_nop 1
    v_mfma_f32_32x32x16_bf16 v[40:55], v[20:23], v[36:39], v[40:55]
    v_exp_f32 v88, v88
    v_exp_f32 v89, v89
    v_exp_f32 v90, v90
    v_exp_f32 v91, v91
    s_waitcnt lgkmcnt(0)
    v_mfma_f32_32x32x16_bf16 v[72:87], v[8:11], v[4:7], v[56:71]
    ds_read_b128 v[12:15], v3 offset:18432
    v_exp_f32 v92, v92
    v_exp_f32 v93, v93
    v_exp_f32 v94, v94
    v_exp_f32 v95, v95
    v_cvt_pk_bf16_f32 v32, v88, v89
    v_cvt_pk_bf16_f32 v33, v90, v91
    v_cvt_pk_bf16_f32 v34, v92, v93
    v_cvt_pk_bf16_f32 v35, v94, v95
    v_exp_f32 v96, v96
    v_exp_f32 v97, v97
    v_mfma_f32_32x32x16_bf16 v[40:55], v[24:27], v[32:35], v[40:55]
    s_mov_b64 exec, s[20:21]
    ds_read_b128 v[16:19], v3 offset:17408
    ds_read_b128 v[20:23], v3 offset:17664
    s_mov_b64 exec, -1
    v_exp_f32 v98, v98
    v_exp_f32 v99, v99
    v_exp_f32 v100, v100
    v_exp_f32 v101, v101
    v_exp_f32 v102, v102
    v_exp_f32 v103, v103
    v_cvt_pk_bf16_f32 v36, v96, v97
    v_cvt_pk_bf16_f32 v37, v98, v99
    v_cvt_pk_bf16_f32 v38, v100, v101
    v_cvt_pk_bf16_f32 v39, v102, v103
    v_add_u32 v3, 16384, v3
    s_add_u32 s23, s23, 1
    s_bitcmp1_b32 s29, s23
    v_mfma_f32_32x32x16_bf16 v[40:55], v[28:31], v[36:39], v[40:55]
    s_cbranch_scc0 P2_loop
    s_cmp_eq_u32 s23, 8
    s_cbranch_scc1 P2_exit
    s_cmp_lg_u32 s23, 1
    s_cbranch_scc1 P2_e5
Lp51:
    ds_read_b32 v109, v108 offset:56
    s_waitcnt lgkmcnt(0)
    v_readfirstlane_b32 s3, v109
    s_cmp_ge_u32 s3, 4
    s_cbranch_scc1 Lq52
    s_sleep 1
    s_branch Lp51
Lq52:
    v_mov_b32 v104, -1
    v_mov_b32 v105, -1
    v_mov_b32 v106, -1
    v_mov_b32 v107, -1
    s_lshl_b32 s19, s16, 10
    s_add_u32 s19, s19, 14680064
    buffer_store_dwordx4 v[104:107], v1, s[8:11], s19 offen sc1
    s_cmp_eq_u32 s63, 0
    s_cbranch_scc1 P2_stK
    buffer_store_dwordx4 v[112:115], v1, s[8:11], s4 offen sc1
    buffer_store_dwordx4 v[116:119], v1, s[8:11], s4 offen offset:1024 sc1
    buffer_store_dwordx4 v[128:131], v1, s[8:11], s5 offen sc1
    buffer_store_dwordx4 v[132:135], v1, s[8:11], s5 offen offset:1024 sc1
    s_branch P2_loop
P2_stK:
    buffer_store_dwordx2 v[136:137], v144, s[8:11], 0 offen sc1
    v_add_u32 v144, v144, v145
    buffer_store_dwordx2 v[138:139], v144, s[8:11], 0 offen sc1
    v_add_u32 v144, v144, v145
    buffer_store_dwordx2 v[140:141], v144, s[8:11], 0 offen sc1
    v_add_u32 v144, v144, v145
    buffer_store_dwordx2 v[142:143], v144, s[8:11], 0 offen sc1
    s_branch P2_loop
P2_e5:
    s_cmp_lg_u32 s23, 2
    s_cbranch_scc1 P2_e6
    s_setprio 2
    s_waitcnt vmcnt(0)
    v_mov_b32 v104, 1
    s_mov_b64 exec, 1
    ds_add_rtn_u32 v104, v108, v104 offset:36
    s_waitcnt lgkmcnt(0)
    v_readfirstlane_b32 s3, v104
    s_mov_b64 exec, -1
    s_cmp_lg_u32 s3, 8
    s_cbranch_scc1 P2_loop
    v_mov_b32 v104, s34
    v_mov_b32 v105, s35
    v_mov_b32 v106, 0
    s_mov_b64 exec, 1
    buffer_store_dwordx2 v[104:105], v106, s[8:11], s62 offen sc1
    s_mov_b64 exec, -1
    s_branch P2_loop
P2_e6:
    s_cmp_lg_u32 s23, 3
    s_cbranch_scc1 P2_e7
Lp53:
    ds_read_b32 v109, v108 offset:76
    s_waitcnt lgkmcnt(0)
    v_readfirstlane_b32 s3, v109
    s_cmp_ge_u32 s3, 4
    s_cbranch_scc1 Lq54
    s_sleep 1
    s_branch Lp53
Lq54:
    s_branch P2_loop
P2_e7:
    s_cmp_lg_u32 s23, 5
    s_cbranch_scc1 P2_e8
    s_setprio 1
    v_mov_b32 v109, 1
    s_mov_b64 exec, 1
    ds_add_u32 v108, v109 offset:80
    s_mov_b64 exec, -1
    s_branch P2_loop
P2_e8:
    s_cmp_ge_u32 s12, 4
    s_cbranch_scc1 P2_loop
    s_setprio 0
    s_branch P2_loop
P2_exit:
    s_waitcnt lgkmcnt(0)
    s_nop 7
    s_nop 1
    v_mov_b32 v32, 0x5f800000
    v_cmp_nlt_f32 s[24:25], v48, v32
    v_mov_b32 v33, 0x7f800000
    v_cmp_nlt_f32 s[26:27], abs(v40), v33
    s_or_b64 s[24:25], s[24:25], s[26:27]
    v_cmp_nlt_f32 s[26:27], abs(v41), v33
    s_or_b64 s[24:25], s[24:25], s[26:27]
    v_cmp_nlt_f32 s[26:27], abs(v42), v33
    s_or_b64 s[24:25], s[24:25], s[26:27]
    v_cmp_nlt_f32 s[26:27], abs(v43), v33
    s_or_b64 s[24:25], s[24:25], s[26:27]
    v_cmp_nlt_f32 s[26:27], abs(v44), v33
    s_or_b64 s[24:25], s[24:25], s[26:27]
    v_cmp_nlt_f32 s[26:27], abs(v45), v33
    s_or_b64 s[24:25], s[24:25], s[26:27]
    v_cmp_nlt_f32 s[26:27], abs(v46), v33
    s_or_b64 s[24:25], s[24:25], s[26:27]
    v_cmp_nlt_f32 s[26:27], abs(v47), v33
    s_or_b64 s[24:25], s[24:25], s[26:27]
    s_cmp_eq_u64 s[24:25], 0
    s_cbranch_scc1 P2_fin
    s_lshl_b32 s17, s13, 17
    s_add_u32 s17, s17, 2097152
    s_mov_b32 s18, s17
    v_mov_b32 v2, 0xff800000
    s_mov_b32 s23, 0
FB_max:
    buffer_load_dwordx4 v[8:11], v1, s[8:11], s18 offen sc1
    s_add_u32 s18, s18, 2048
    s_add_u32 s23, s23, 1
    s_waitcnt vmcnt(0)
    v_mfma_f32_32x32x16_bf16 v[72:87], v[8:11], v[4:7], 0
    s_nop 7
    s_nop 3
    v_max3_f32 v2, v2, v72, v73
    v_max3_f32 v2, v2, v74, v75
    v_max3_f32 v2, v2, v76, v77
    v_max3_f32 v2, v2, v78, v79
    v_max3_f32 v2, v2, v80, v81
    v_max3_f32 v2, v2, v82, v83
    v_max3_f32 v2, v2, v84, v85
    v_max3_f32 v2, v2, v86, v87
    s_cmp_lt_u32 s23, 64
    s_cbranch_scc1 FB_max
    v_mov_b32 v3, v2
    s_nop 1
    v_permlane32_swap_b32 v2, v3
    s_nop 1
    v_max_f32 v2, v2, v3
    v_sub_f32 v56, 0, v2
    v_sub_f32 v57, 0, v2
    v_mov_b64 v[58:59], v[56:57]
    v_mov_b64 v[60:61], v[56:57]
    v_mov_b64 v[62:63], v[56:57]
    v_mov_b64 v[64:65], v[56:57]
    v_mov_b64 v[66:67], v[56:57]
    v_mov_b64 v[68:69], v[56:57]
    v_mov_b64 v[70:71], v[56:57]
    v_mov_b64 v[40:41], 0
    v_mov_b64 v[42:43], 0
    v_mov_b64 v[44:45], 0
    v_mov_b64 v[46:47], 0
    v_mov_b64 v[48:49], 0
    v_mov_b64 v[50:51], 0
    v_mov_b64 v[52:53], 0
    v_mov_b64 v[54:55], 0
    s_mov_b32 s23, 0
FB_main:
    buffer_load_dwordx4 v[8:11], v1, s[8:11], s17 offen sc1
    s_mov_b64 exec, s[20:21]
    buffer_load_dwordx4 v[16:19], v1, s[8:11], s17 offen offset:1024 sc1
    buffer_load_dwordx4 v[20:23], v1, s[8:11], s17 offen offset:1280 sc1
    s_mov_b64 exec, -1
    s_add_u32 s17, s17, 2048
    s_add_u32 s23, s23, 1
    s_waitcnt vmcnt(0)
    v_mfma_f32_32x32x16_bf16 v[72:87], v[8:11], v[4:7], v[56:71]
    s_nop 7
    s_nop 3
    v_exp_f32 v72, v72
    v_exp_f32 v73, v73
    v_exp_f32 v74, v74
    v_exp_f32 v75, v75
    v_exp_f32 v76, v76
    v_exp_f32 v77, v77
    v_exp_f32 v78, v78
    v_exp_f32 v79, v79
    v_exp_f32 v80, v80
    v_exp_f32 v81, v81
    v_exp_f32 v82, v82
    v_exp_f32 v83, v83
    v_exp_f32 v84, v84
    v_exp_f32 v85, v85
    v_exp_f32 v86, v86
    v_exp_f32 v87, v87
    s_nop 0
    v_cvt_pk_bf16_f32 v32, v72, v73
    v_cvt_pk_bf16_f32 v33, v74, v75
    v_cvt_pk_bf16_f32 v34, v76, v77
    v_cvt_pk_bf16_f32 v35, v78, v79
    v_cvt_pk_bf16_f32 v36, v80, v81
    v_cvt_pk_bf16_f32 v37, v82, v83
    v_cvt_pk_bf16_f32 v38, v84, v85
    v_cvt_pk_bf16_f32 v39, v86, v87
    s_nop 1
    v_mfma_f32_32x32x16_bf16 v[40:55], v[16:19], v[32:35], v[40:55]
    v_mfma_f32_32x32x16_bf16 v[40:55], v[20:23], v[36:39], v[40:55]
    s_cmp_lt_u32 s23, 64
    s_cbranch_scc1 FB_main
    s_nop 7
    s_nop 3
P2_fin:
    v_rcp_f32 v2, v48
    s_lshl_b32 s19, s16, 10
    v_pk_mul_f32 v[40:41], v[40:41], v[2:3] op_sel_hi:[1,0]
    v_pk_mul_f32 v[42:43], v[42:43], v[2:3] op_sel_hi:[1,0]
    v_pk_mul_f32 v[44:45], v[44:45], v[2:3] op_sel_hi:[1,0]
    v_pk_mul_f32 v[46:47], v[46:47], v[2:3] op_sel_hi:[1,0]
    v_cvt_pk_bf16_f32 v160, v40, v41
    v_cvt_pk_bf16_f32 v161, v42, v43
    v_cvt_pk_bf16_f32 v162, v44, v45
    v_cvt_pk_bf16_f32 v163, v46, v47
    s_add_u32 s19, s19, 14680064
    v_min_u32 v160, 0xfffffffe, v160
    v_min_u32 v161, 0xfffffffe, v161
    v_min_u32 v162, 0xfffffffe, v162
    v_min_u32 v163, 0xfffffffe, v163
    buffer_store_dwordx4 v[160:163], v1, s[8:11], s19 offen sc1
    s_setprio 3
    v_mov_b32 v2, v108
    v_mov_b32 v3, 1
    s_mov_b64 exec, 1
    ds_add_u32 v2, v3 offset:12
    s_mov_b64 exec, -1
Lp55:
    ds_read_b32 v3, v2 offset:8
    s_waitcnt lgkmcnt(0)
    v_readfirstlane_b32 s3, v3
    s_cmp_ge_u32 s3, 1
    s_cbranch_scc1 Lq56
    s_sleep 1
    s_branch Lp55
Lq56:
    s_lshl_b32 s3, s12, 13
    s_add_u32 s3, s3, 65536
    v_add_u32 v4, s3, v1
Lp57:
    ds_read_b32 v3, v2 offset:12
    s_waitcnt lgkmcnt(0)
    v_readfirstlane_b32 s3, v3
    s_cmp_ge_u32 s3, 8
    s_cbranch_scc1 Lq58
    s_sleep 1
    s_branch Lp57
Lq58:
    s_waitcnt vmcnt(0)
    s_mov_b32 s31, 0
    s_mov_b32 s30, 0xf
P3_round:
    s_bitcmp1_b32 s30, 0
    s_cbranch_scc0 P3_s0
    s_add_u32 s3, s47, 0
    buffer_load_dwordx4 v[80:83], v1, s[8:11], s3 offen sc1
    buffer_load_dwordx4 v[84:87], v1, s[8:11], s3 offen offset:1024 sc1
P3_s0:
    s_bitcmp1_b32 s30, 1
    s_cbranch_scc0 P3_s1
    s_add_u32 s3, s47, 65536
    buffer_load_dwordx4 v[88:91], v1, s[8:11], s3 offen sc1
    buffer_load_dwordx4 v[92:95], v1, s[8:11], s3 offen offset:1024 sc1
P3_s1:
    s_bitcmp1_b32 s30, 2
    s_cbranch_scc0 P3_s2
    s_add_u32 s3, s47, 131072
    buffer_load_dwordx4 v[96:99], v1, s[8:11], s3 offen sc1
    buffer_load_dwordx4 v[100:103], v1, s[8:11], s3 offen offset:1024 sc1
P3_s2:
    s_bitcmp1_b32 s30, 3
    s_cbranch_scc0 P3_s3
    s_add_u32 s3, s47, 196608
    buffer_load_dwordx4 v[104:107], v1, s[8:11], s3 offen sc1
    buffer_load_dwordx4 v[108:111], v1, s[8:11], s3 offen offset:1024 sc1
P3_s3:
    s_add_u32 s31, s31, 1
    s_mov_b32 s30, 0
    s_waitcnt vmcnt(0)
    v_max3_u32 v5, v80, v81, v82
    v_max3_u32 v6, v83, v84, v85
    v_max3_u32 v5, v5, v86, v87
    v_max_u32 v5, v5, v6
    v_cmp_eq_u32 s[24:25], -1, v5
    s_nop 0
    s_cmp_lg_u64 s[24:25], 0
    s_cselect_b32 s3, 1, 0
    s_or_b32 s30, s30, s3
    v_max3_u32 v5, v88, v89, v90
    v_max3_u32 v6, v91, v92, v93
    v_max3_u32 v5, v5, v94, v95
    v_max_u32 v5, v5, v6
    v_cmp_eq_u32 s[24:25], -1, v5
    s_nop 0
    s_cmp_lg_u64 s[24:25], 0
    s_cselect_b32 s3, 2, 0
    s_or_b32 s30, s30, s3
    v_max3_u32 v5, v96, v97, v98
    v_max3_u32 v6, v99, v100, v101
    v_max3_u32 v5, v5, v102, v103
    v_max_u32 v5, v5, v6
    v_cmp_eq_u32 s[24:25], -1, v5
    s_nop 0
    s_cmp_lg_u64 s[24:25], 0
    s_cselect_b32 s3, 4, 0
    s_or_b32 s30, s30, s3
    v_max3_u32 v5, v104, v105, v106
    v_max3_u32 v6, v107, v108, v109
    v_max3_u32 v5, v5, v110, v111
    v_max_u32 v5, v5, v6
    v_cmp_eq_u32 s[24:25], -1, v5
    s_nop 0
    s_cmp_lg_u64 s[24:25], 0
    s_cselect_b32 s3, 8, 0
    s_or_b32 s30, s30, s3
    s_cmp_gt_u32 s31, 0x200000
    s_cbranch_scc1 P3_out
    s_cmp_eq_u32 s30, 0
    s_cbranch_scc1 P3_out
    s_sleep 4
    s_branch P3_round
P3_out:
    ds_write_b128 v4, v[80:83] offset:0
    ds_write_b128 v4, v[84:87] offset:1024
    ds_write_b128 v4, v[88:91] offset:2048
    ds_write_b128 v4, v[92:95] offset:3072
    ds_write_b128 v4, v[96:99] offset:4096
    ds_write_b128 v4, v[100:103] offset:5120
    ds_write_b128 v4, v[104:107] offset:6144
    ds_write_b128 v4, v[108:111] offset:7168
    s_lshl_b32 s3, 1, s12
    v_mov_b32 v3, s3
    s_waitcnt lgkmcnt(0)
    s_mov_b64 exec, 1
    ds_or_b32 v2, v3 offset:88
    s_mov_b64 exec, -1
K_end:
K_last:
    s_endpgm
.section .rodata,"a"
.p2align 6
.amdhsa_kernel gated_mix__linear_kernel_hedgehog__softmax_full_mha__prompt_kernel
  .amdhsa_next_free_vgpr 168
  .amdhsa_next_free_sgpr 80
  .amdhsa_accum_offset 168
  .amdhsa_group_segment_fixed_size 0
  .amdhsa_kernarg_size 88
  .amdhsa_user_sgpr_count 2
  .amdhsa_user_sgpr_kernarg_segment_ptr 1
  .amdhsa_system_sgpr_workgroup_id_x 1
.end_amdhsa_kernel
```
